```python
import torch

def _softmax(x, axis=-1):
    return torch.softmax(x, dim=axis)

def _gelu(x):
    return torch.nn.functional.gelu(x, approximate='tanh')

def _silu(x):
    return torch.nn.functional.silu(x)

def _sigmoid(x):
    return torch.sigmoid(x)

def _layernorm(x, axis=-1, eps=1e-05):
    m = x.mean(dim=axis, keepdim=True)
    v = x.var(dim=axis, keepdim=True, unbiased=False)
    return (x - m) / torch.sqrt(v + eps)

def _scatter_add(tgt, idx, src, axis=0):
    return tgt.clone().index_add_(axis, idx, src)

def _segment_sum(src, seg, n):
    out = torch.zeros((n,) + src.shape[1:], dtype=src.dtype)
    return out.index_add_(0, seg, src)

def _pad(x, pw):
    flat = tuple((v for pair in reversed(pw) for v in pair))
    return torch.nn.functional.pad(x, flat)
kernel_name = 'standalone__video_video_swin__vision'

def setup_inputs():

    _w = lambda a: (lambda t: t.to(torch.bfloat16) if t.is_floating_point() else t)(torch.as_tensor(a))
    T = 4
    H = W = 384 // 7 * 7
    C, win = (96, 7)
    return {'x': _w((lambda *s: torch.randn(*s, dtype=torch.bfloat16) * 0.1)(1, T, H, W, C)), 'wqkv_t': _w((lambda *s: torch.randn(*s, dtype=torch.bfloat16) * 0.1)(C, 3 * C)), 'wo_t': _w((lambda *s: torch.randn(*s, dtype=torch.bfloat16) * 0.1)(C, C)), 'wqkv_s': _w((lambda *s: torch.randn(*s, dtype=torch.bfloat16) * 0.1)(C, 3 * C)), 'wo_s': _w((lambda *s: torch.randn(*s, dtype=torch.bfloat16) * 0.05)(C, C))}

def reference(x, wqkv_t, wo_t, wqkv_s, wo_s):
    B, T, H, W, C = x.shape
    win = 7
    scale = C ** (-0.5)
    h = _layernorm(x, axis=-1)
    ht = (lambda x, *d: x.permute(*d))(h, 0, 2, 3, 1, 4).reshape(B * H * W, T, C)
    qkv = ht @ wqkv_t
    q, k, v = (qkv[..., :C].clone(), qkv[..., C:2 * C].clone(), qkv[..., 2 * C:].clone())
    p = _softmax(torch.einsum('btc,bsc->bts', q, k) * scale, axis=-1)
    ot = torch.einsum('bts,bsc->btc', p, v) @ wo_t
    ot = (lambda x, *d: x.permute(*d))(ot.reshape(B, H, W, T, C), 0, 3, 1, 2, 4)
    x = x + ot
    h = _layernorm(x, axis=-1)
    nh, nw = (H // win, W // win)
    hs = h.reshape(B * T, nh, win, nw, win, C)
    hw = (lambda x, *d: x.permute(*d))(hs, 0, 1, 3, 2, 4, 5).reshape(B * T * nh * nw, win * win, C)
    qkv = hw @ wqkv_s
    q, k, v = (qkv[..., :C].clone(), qkv[..., C:2 * C].clone(), qkv[..., 2 * C:].clone())
    p = _softmax(torch.einsum('bqc,bkc->bqk', q, k) * scale, axis=-1)
    os = torch.einsum('bqk,bkc->bqc', p, v) @ wo_s
    os = (lambda x, *d: x.permute(*d))(os.reshape(B * T, nh, nw, win, win, C), 0, 1, 3, 2, 4, 5)
    os = os.reshape(B, T, H, W, C)
    return x + os
```

```asm
; @launch grid=(256,1,1) block=(256,1,1) lds=162256
.amdgcn_target "amdgcn-amd-amdhsa--gfx950"
.text
.globl standalone__video_video_swin__vision_kernel
.p2align 8
.type standalone__video_video_swin__vision_kernel,@function
standalone__video_video_swin__vision_kernel:
    s_cmp_ge_u32 s2, 256
    s_cbranch_scc1 L_end
    s_load_dwordx4 s[56:59], s[0:1], 0
    s_load_dwordx4 s[60:63], s[0:1], 16
    s_load_dwordx4 s[64:67], s[0:1], 32
    v_and_b32 v1, 63, v0
    v_lshrrev_b32 v5, 6, v0
    s_nop 0
    v_readfirstlane_b32 s20, v5
    s_getpc_b64 s[68:69]
    v_lshlrev_b32_e64 v2, 6, v0
L_pf:
    global_load_dword a250, v2, s[68:69]
    v_min_u32 v2, L_end-L_pf-16384, v2
    s_add_u32 s68, s68, 16384
    s_addc_u32 s69, s69, 0
    global_load_dword a251, v2, s[68:69]
    v_and_b32 v2, 15, v1
    v_lshrrev_b32 v4, 4, v1
    v_lshlrev_b32 v3, 4, v1
    v_mov_b32 v6, 0x78
    v_lshrrev_b32 v7, 2, v2
    v_and_b32 v15, 3, v2
    v_lshl_add_u32 v7, v7, 3, v15
    v_mul_u32_u24 v50, 576, v7
    v_lshl_add_u32 v50, v4, 4, v50
    v_mul_u32_u24 v7, 576, v2
    v_lshl_add_u32 v7, v4, 4, v7
    s_mul_i32 s48, s2, 9
    s_sub_u32 s48, s48, 899
    s_mul_hi_u32 s49, s48, 42949673
    s_mul_i32 s49, s49, 100
    s_sub_u32 s48, s48, s49
    s_cmp_lt_u32 s2, 100
    s_cselect_b32 s48, s2, s48
    s_sub_u32 s49, s2, 198
    s_cmp_ge_u32 s2, 200
    s_cselect_b32 s48, s49, s48
    s_add_u32 s53, s48, 2816
    s_mov_b32 s21, 11
    s_mov_b32 s55, 0
    s_mul_i32 s31, s2, 1
    s_add_u32 s3, s31, 2816
    s_mul_hi_u32 s48, s31, 79536432
    s_mul_i32 s49, s48, 54
    s_sub_u32 s49, s31, s49
    s_mul_i32 s48, s48, 508032
    s_mul_i32 s49, s49, 1344
    s_add_u32 s26, s48, s49
    s_add_u32 s23, s31, 256
    s_mul_hi_u32 s48, s23, 79536432
    s_mul_i32 s49, s48, 54
    s_sub_u32 s49, s23, s49
    s_mul_i32 s48, s48, 508032
    s_mul_i32 s49, s49, 1344
    s_add_u32 s25, s48, s49
    s_add_u32 s23, s23, 256
    s_mul_hi_u32 s48, s23, 79536432
    s_mul_i32 s49, s48, 54
    s_sub_u32 s49, s23, s49
    s_mul_i32 s48, s48, 508032
    s_mul_i32 s49, s49, 1344
    s_add_u32 s24, s48, s49
    s_mov_b32 s27, s26
    s_mov_b32 s51, 0x3a7ba882
    s_mov_b32 s28, 0
    s_mov_b32 s29, 37632
    s_mov_b32 s30, 75264
    s_mul_i32 s43, s20, 9216
    s_waitcnt lgkmcnt(0)
    s_mov_b32 s4, s56
    s_mov_b32 s5, s57
    s_mov_b32 s8, s66
    s_mov_b32 s9, s67
    s_mov_b32 s6, 109734912
    s_mov_b32 s7, 0x00020000
    s_mov_b32 s10, 0
    s_mov_b32 s11, 0x00020000
    s_cmp_ge_u32 s20, 2
    s_cselect_b32 s12, s62, s58
    s_cselect_b32 s13, s63, s59
    s_cselect_b32 s16, s64, s60
    s_cselect_b32 s17, s65, s61
    s_mov_b32 s14, 55296
    s_mov_b32 s15, 0x00020000
    s_mov_b32 s18, 18432
    s_mov_b32 s19, 0x00020000
    s_mov_b32 s50, 112896
    s_cselect_b32 s50, 140736, s50
    s_and_b32 s46, s20, 1
    s_mul_i32 s47, s46, 384
    s_cbranch_scc1 L_fold_a
    s_nop 0
    s_mov_b32 s52, 192
    buffer_load_dwordx4 a[72:75], v7, s[12:15], s52 offen offset:0
    buffer_load_dwordx4 a[76:79], v7, s[12:15], s52 offen offset:64
    buffer_load_dwordx4 a[80:83], v7, s[12:15], s52 offen offset:128
    s_mov_b32 s52, 9408
    buffer_load_dwordx4 a[84:87], v7, s[12:15], s52 offen offset:0
    buffer_load_dwordx4 a[88:91], v7, s[12:15], s52 offen offset:64
    buffer_load_dwordx4 a[92:95], v7, s[12:15], s52 offen offset:128
    s_mov_b32 s52, 18624
    buffer_load_dwordx4 a[96:99], v7, s[12:15], s52 offen offset:0
    buffer_load_dwordx4 a[100:103], v7, s[12:15], s52 offen offset:64
    buffer_load_dwordx4 a[104:107], v7, s[12:15], s52 offen offset:128
    s_mov_b32 s52, 27840
    buffer_load_dwordx4 a[108:111], v7, s[12:15], s52 offen offset:0
    buffer_load_dwordx4 a[112:115], v7, s[12:15], s52 offen offset:64
    buffer_load_dwordx4 a[116:119], v7, s[12:15], s52 offen offset:128
    s_mov_b32 s52, 37056
    buffer_load_dwordx4 a[120:123], v7, s[12:15], s52 offen offset:0
    buffer_load_dwordx4 a[124:127], v7, s[12:15], s52 offen offset:64
    buffer_load_dwordx4 a[128:131], v7, s[12:15], s52 offen offset:128
    s_mov_b32 s52, 46272
    buffer_load_dwordx4 a[132:135], v7, s[12:15], s52 offen offset:0
    buffer_load_dwordx4 a[136:139], v7, s[12:15], s52 offen offset:64
    buffer_load_dwordx4 a[140:143], v7, s[12:15], s52 offen offset:128
    s_branch L_fold_c
L_fold_a:
    s_add_u32 m0, s50, 0
    s_mov_b32 s52, 0
    s_nop 0
    buffer_load_dwordx4 v3, s[16:19], s52 offen lds
    s_add_u32 m0, s50, 1024
    s_mov_b32 s52, 1024
    buffer_load_dwordx4 v3, s[16:19], s52 offen lds
    s_add_u32 m0, s50, 2048
    s_mov_b32 s52, 2048
    buffer_load_dwordx4 v3, s[16:19], s52 offen lds
    s_add_u32 m0, s50, 3072
    s_mov_b32 s52, 3072
    buffer_load_dwordx4 v3, s[16:19], s52 offen lds
    s_add_u32 m0, s50, 4096
    s_mov_b32 s52, 4096
    buffer_load_dwordx4 v3, s[16:19], s52 offen lds
    s_add_u32 m0, s50, 5120
    s_mov_b32 s52, 5120
    buffer_load_dwordx4 v3, s[16:19], s52 offen lds
    s_add_u32 m0, s50, 6144
    s_mov_b32 s52, 6144
    buffer_load_dwordx4 v3, s[16:19], s52 offen lds
    s_add_u32 m0, s50, 7168
    s_mov_b32 s52, 7168
    buffer_load_dwordx4 v3, s[16:19], s52 offen lds
    s_add_u32 m0, s50, 8192
    s_mov_b32 s52, 8192
    buffer_load_dwordx4 v3, s[16:19], s52 offen lds
    s_add_u32 m0, s50, 9216
    s_mov_b32 s52, 9216
    buffer_load_dwordx4 v3, s[16:19], s52 offen lds
    s_add_u32 m0, s50, 10240
    s_mov_b32 s52, 10240
    buffer_load_dwordx4 v3, s[16:19], s52 offen lds
    s_add_u32 m0, s50, 11264
    s_mov_b32 s52, 11264
    buffer_load_dwordx4 v3, s[16:19], s52 offen lds
    s_add_u32 m0, s50, 12288
    s_mov_b32 s52, 12288
    buffer_load_dwordx4 v3, s[16:19], s52 offen lds
    s_add_u32 m0, s50, 13312
    s_mov_b32 s52, 13312
    buffer_load_dwordx4 v3, s[16:19], s52 offen lds
    s_add_u32 m0, s50, 14336
    s_mov_b32 s52, 14336
    buffer_load_dwordx4 v3, s[16:19], s52 offen lds
    s_add_u32 m0, s50, 15360
    s_mov_b32 s52, 15360
    buffer_load_dwordx4 v3, s[16:19], s52 offen lds
    s_add_u32 m0, s50, 16384
    s_mov_b32 s52, 16384
    buffer_load_dwordx4 v3, s[16:19], s52 offen lds
    s_add_u32 m0, s50, 17408
    s_mov_b32 s52, 17408
    buffer_load_dwordx4 v3, s[16:19], s52 offen lds
L_fold_c:
    v_add_u32 v14, 0, v1
    v_mul_u32_u24 v8, 5462, v14
    v_lshrrev_b32 v8, 16, v8
    v_lshrrev_b32 v7, 2, v8
    v_and_b32 v13, 3, v7
    v_lshlrev_b32 v13, 1, v13
    v_lshrrev_b32 v13, v13, v6
    v_bfe_u32 v7, v8, 1, 1
    v_xor_b32 v13, v13, v7
    v_mul_u32_u24 v9, 12, v8
    v_xor_b32 v13, v13, v5
    v_mul_u32_u24 v11, 9363, v8
    s_mul_i32 s48, s20, 27433728
    v_sub_u32 v9, v14, v9
    v_and_b32 v13, 3, v13
    v_lshrrev_b32 v11, 16, v11
    v_mov_b32 v10, s48
    v_xor_b32 v9, v9, v13
    v_mul_u32_u24 v11, 71232, v11
    v_mul_u32_u24 v7, 192, v8
    v_add_u32 v14, 64, v1
    v_add_u32 v7, v7, v11
    v_lshl_add_u32 v15, v9, 4, v10
    v_mul_u32_u24 v8, 5462, v14
    v_add_u32 v212, v7, v15
    v_lshrrev_b32 v8, 16, v8
    v_lshrrev_b32 v7, 2, v8
    v_and_b32 v13, 3, v7
    v_lshlrev_b32 v13, 1, v13
    v_lshrrev_b32 v13, v13, v6
    v_bfe_u32 v7, v8, 1, 1
    v_xor_b32 v13, v13, v7
    v_mul_u32_u24 v9, 12, v8
    v_xor_b32 v13, v13, v5
    v_mul_u32_u24 v11, 9363, v8
    v_sub_u32 v9, v14, v9
    v_and_b32 v13, 3, v13
    v_lshrrev_b32 v11, 16, v11
    v_xor_b32_e64 v9, v9, v13
    v_mul_u32_u24 v11, 71232, v11
    v_mul_u32_u24 v7, 192, v8
    v_add_u32 v14, 128, v1
    v_add_u32 v7, v7, v11
    v_lshl_add_u32 v15, v9, 4, v10
    v_mul_u32_u24 v8, 5462, v14
    v_add_u32 v213, v7, v15
    v_lshrrev_b32 v8, 16, v8
    v_lshrrev_b32 v7, 2, v8
    v_and_b32 v13, 3, v7
    v_lshlrev_b32 v13, 1, v13
    v_lshrrev_b32 v13, v13, v6
    v_bfe_u32 v7, v8, 1, 1
    v_xor_b32 v13, v13, v7
    v_mul_u32_u24 v9, 12, v8
    v_xor_b32 v13, v13, v5
    v_mul_u32_u24 v11, 9363, v8
    v_sub_u32 v9, v14, v9
    v_and_b32 v13, 3, v13
    v_lshrrev_b32 v11, 16, v11
    v_xor_b32 v9, v9, v13
    v_mul_u32_u24 v11, 71232, v11
    v_mul_u32_u24 v7, 192, v8
    v_add_u32 v14, 192, v1
    v_add_u32 v7, v7, v11
    v_lshl_add_u32 v15, v9, 4, v10
    v_mul_u32_u24 v8, 5462, v14
    v_add_u32 v214, v7, v15
    v_lshrrev_b32 v8, 16, v8
    v_lshrrev_b32 v7, 2, v8
    v_and_b32 v13, 3, v7
    v_lshlrev_b32 v13, 1, v13
    v_lshrrev_b32 v13, v13, v6
    v_bfe_u32 v7, v8, 1, 1
    v_xor_b32 v13, v13, v7
    v_mul_u32_u24 v9, 12, v8
    v_xor_b32 v13, v13, v5
    v_mul_u32_u24 v11, 9363, v8
    v_sub_u32 v9, v14, v9
    v_and_b32 v13, 3, v13
    v_lshrrev_b32 v11, 16, v11
    v_xor_b32 v9, v9, v13
    v_mul_u32_u24 v11, 71232, v11
    v_mul_u32_u24 v7, 192, v8
    v_add_u32 v14, 256, v1
    v_add_u32 v7, v7, v11
    v_lshl_add_u32 v15, v9, 4, v10
    v_mul_u32_u24 v8, 5462, v14
    v_add_u32 v215, v7, v15
    v_lshrrev_b32 v8, 16, v8
    v_lshrrev_b32 v7, 2, v8
    v_and_b32 v13, 3, v7
    v_lshlrev_b32 v13, 1, v13
    v_lshrrev_b32 v13, v13, v6
    v_bfe_u32 v7, v8, 1, 1
    v_xor_b32 v13, v13, v7
    v_mul_u32_u24 v9, 12, v8
    v_xor_b32 v13, v13, v5
    v_mul_u32_u24 v11, 9363, v8
    v_sub_u32 v9, v14, v9
    v_and_b32 v13, 3, v13
    v_lshrrev_b32 v11, 16, v11
    v_xor_b32 v9, v9, v13
    v_mul_u32_u24 v11, 71232, v11
    v_mul_u32_u24 v7, 192, v8
    v_add_u32 v14, 320, v1
    v_add_u32 v7, v7, v11
    v_lshl_add_u32 v15, v9, 4, v10
    v_mul_u32_u24 v8, 5462, v14
    v_add_u32 v216, v7, v15
    v_lshrrev_b32 v8, 16, v8
    v_lshrrev_b32 v7, 2, v8
    v_and_b32 v13, 3, v7
    v_lshlrev_b32 v13, 1, v13
    v_lshrrev_b32 v13, v13, v6
    v_bfe_u32 v7, v8, 1, 1
    v_xor_b32 v13, v13, v7
    v_mul_u32_u24 v9, 12, v8
    v_xor_b32 v13, v13, v5
    v_mul_u32_u24 v11, 9363, v8
    v_sub_u32 v9, v14, v9
    v_and_b32 v13, 3, v13
    v_lshrrev_b32 v11, 16, v11
    v_xor_b32 v9, v9, v13
    v_mul_u32_u24 v11, 71232, v11
    v_mul_u32_u24 v7, 192, v8
    v_add_u32 v14, 384, v1
    v_add_u32 v7, v7, v11
    v_lshl_add_u32 v15, v9, 4, v10
    v_mul_u32_u24 v8, 5462, v14
    v_add_u32 v217, v7, v15
    v_lshrrev_b32 v8, 16, v8
    v_lshrrev_b32 v7, 2, v8
    v_and_b32 v13, 3, v7
    v_lshlrev_b32 v13, 1, v13
    v_lshrrev_b32 v13, v13, v6
    v_bfe_u32 v7, v8, 1, 1
    v_xor_b32 v13, v13, v7
    v_mul_u32_u24 v9, 12, v8
    v_xor_b32 v13, v13, v5
    v_mul_u32_u24 v11, 9363, v8
    v_sub_u32 v9, v14, v9
    v_and_b32 v13, 3, v13
    v_lshrrev_b32 v11, 16, v11
    v_xor_b32 v9, v9, v13
    v_mul_u32_u24 v11, 71232, v11
    v_mul_u32_u24 v7, 192, v8
    v_add_u32 v14, 448, v1
    v_add_u32 v7, v7, v11
    v_lshl_add_u32 v15, v9, 4, v10
    v_mul_u32_u24 v8, 5462, v14
    v_add_u32 v218, v7, v15
    v_lshrrev_b32 v8, 16, v8
    v_lshrrev_b32 v7, 2, v8
    v_and_b32 v13, 3, v7
    v_lshlrev_b32 v13, 1, v13
    v_lshrrev_b32 v13, v13, v6
    v_bfe_u32 v7, v8, 1, 1
    v_xor_b32 v13, v13, v7
    v_mul_u32_u24 v9, 12, v8
    v_xor_b32 v13, v13, v5
    v_mul_u32_u24 v11, 9363, v8
    v_sub_u32 v9, v14, v9
    v_and_b32 v13, 3, v13
    v_lshrrev_b32 v11, 16, v11
    v_xor_b32 v9, v9, v13
    v_mul_u32_u24 v11, 71232, v11
    v_mul_u32_u24 v7, 192, v8
    v_add_u32 v14, 512, v1
    v_add_u32 v7, v7, v11
    v_lshl_add_u32 v15, v9, 4, v10
    v_mul_u32_u24 v8, 5462, v14
    v_add_u32 v219, v7, v15
    v_lshrrev_b32 v8, 16, v8
    v_lshrrev_b32 v7, 2, v8
    v_and_b32 v13, 3, v7
    v_lshlrev_b32 v13, 1, v13
    v_lshrrev_b32 v13, v13, v6
    v_bfe_u32 v7, v8, 1, 1
    v_xor_b32 v13, v13, v7
    v_mul_u32_u24 v9, 12, v8
    v_xor_b32 v13, v13, v5
    v_mul_u32_u24 v11, 9363, v8
    v_sub_u32 v9, v14, v9
    v_and_b32 v13, 3, v13
    v_lshrrev_b32 v11, 16, v11
    v_xor_b32 v9, v9, v13
    v_mul_u32_u24 v11, 71232, v11
    v_mul_u32_u24 v7, 192, v8
    v_add_u32 v7, v7, v11
    v_lshl_add_u32 v15, v9, 4, v10
    v_cmp_eq_u32 s[68:69], 0, v1
    v_add_u32 v220, v7, v15
    v_mov_b32 v12, 1073741824
    v_mov_b32 v7, 162244
    v_cndmask_b32_e64 v210, v12, v7, s[68:69]
    v_mov_b32 v7, 0
    ds_write_b32 v210, v7
    v_cmp_eq_u32 s[70:71], 0, v2
    v_and_b32_e64 v9, 3, v2
    v_lshl_add_u32 v7, v4, 4, v10
    v_add_u32 v7, 436608, v7
    v_cmp_eq_u32 s[68:69], 0, v9
    v_cndmask_b32_e64 v221, v12, v7, s[70:71]
    v_mul_u32_u24 v8, 192, v5
    v_add_u32 v8, 112896, v8
    v_mov_b32 v7, 0x3f803f80
    v_cmp_eq_u32 s[70:71], 1, v5
    v_lshl_add_u32 v15, v4, 4, v8
    v_cndmask_b32_e64 v192, 0, v7, s[68:69]
    v_cndmask_b32_e64 v222, v12, v15, s[68:69]
    v_add_u32 v7, 159168, v3
    v_lshrrev_b32_e64 v11, 2, v2
    v_cndmask_b32_e64 v1, v12, v7, s[70:71]
    v_cmp_eq_u32 s[68:69], v9, v4
    v_lshl_add_u32 v7, v11, 3, v8
    v_add_u32 v7, 1536, v7
    v_cndmask_b32_e64 v223, v12, v7, s[68:69]
    v_cmp_eq_u32 s[68:69], 3, v11
    v_lshlrev_b32_e64 v7, 2, v5
    v_add_u32 v224, 115200, v7
    v_mul_u32_u24 v10, 192, v5
    v_cndmask_b32_e64 v7, v11, 0, s[68:69]
    v_add_u32 v10, 36864, v10
    v_cmp_eq_u32 s[68:69], 0, v9
    v_and_b32 v13, 3, v11
    v_lshl_add_u32 v227, v4, 4, v10
    v_lshlrev_b32 v13, 1, v13
    v_lshl_add_u32 v7, v7, 6, v227
    v_lshrrev_b32 v13, v13, v6
    v_cndmask_b32_e64 v229, v12, v7, s[68:69]
    v_xor_b32 v13, v13, v4
    v_xor_b32 v13, v13, v5
    v_bfe_u32 v7, v2, 1, 1
    v_xor_b32 v13, v13, v7
    v_mul_u32_u24 v15, 192, v2
    v_and_b32 v7, 3, v13
    v_cmp_eq_u32 s[68:69], 0, v4
    v_lshl_add_u32 v7, v7, 4, v15
    v_add_u32 v226, s43, v7
    v_mov_b32 v8, 0xffff
    v_cmp_eq_u32 s[70:71], 1, v4
    v_cndmask_b32_e64 v7, 0, v8, s[68:69]
    v_mov_b32 v13, 0xffff0000
    v_cmp_eq_u32 s[68:69], 2, v4
    v_cndmask_b32_e64 v236, v7, v13, s[70:71]
    v_cmp_eq_u32 s[70:71], 3, v4
    v_cndmask_b32_e64 v7, 0, v8, s[68:69]
    v_lshl_add_u32 v8, v5, 2, v11
    v_cmp_eq_u32 s[68:69], 11, v8
    v_cndmask_b32_e64 v237, v7, v13, s[70:71]
    v_mul_u32_u24 v13, 256, v8
    v_add_u32 v13, s31, v13
    v_mov_b32 v7, s53
    v_cndmask_b32_e64 v13, v13, v7, s[68:69]
    s_mov_b32 s48, 79536432
    v_mul_hi_u32 v7, v13, s48
    v_mul_u32_u24 v15, 54, v7
    v_sub_u32 v15, v13, v15
    s_mov_b32 s49, 508032
    s_mov_b32 s48, 27433728
    v_mul_lo_u32 v7, v7, s49
    v_mul_u32_u24 v15, 1344, v15
    v_mul_lo_u32 v14, v9, s48
    v_add3_u32 v7, v7, v15, v14
    v_cmp_gt_u32 s[68:69], 12, v8
    v_add_u32 v7, 436608, v7
    v_lshl_add_u32 v7, v4, 4, v7
    v_cndmask_b32_e64 v138, v12, v7, s[68:69]
    v_mul_u32_u24 v7, 2320, v8
    v_mul_u32_u24 v15, 192, v9
    v_add_u32 v7, 112896, v7
    v_cmp_gt_u32 s[68:69], 12, v8
    v_add_u32 v7, v7, v15
    v_lshl_add_u32 v15, v4, 4, v7
    v_cndmask_b32_e64 v209, v12, v15, s[68:69]
    v_mul_u32_u24 v8, 12, v5
    v_lshl_add_u32 v15, v4, 3, v7
    v_add3_u32 v8, v8, v11, 0
    v_lshrrev_b32 v7, 2, v8
    v_and_b32 v13, 3, v7
    v_lshlrev_b32 v13, 1, v13
    v_lshrrev_b32 v13, v13, v6
    v_bfe_u32 v7, v8, 1, 1
    v_xor_b32 v13, v13, v7
    v_cndmask_b32_e64 v208, v12, v15, s[68:69]
    v_xor_b32 v13, v13, v9
    v_xor_b32 v13, v13, v4
    v_mul_u32_u24 v7, 9216, v9
    v_mul_u32_u24 v15, 192, v8
    v_and_b32 v13, 3, v13
    v_add_u32 v7, v7, v15
    v_mul_u32_u24 v8, 12, v5
    v_lshl_add_u32 v232, v13, 4, v7
    v_add3_u32 v8, v8, v11, 4
    v_lshrrev_b32 v7, 2, v8
    v_and_b32 v13, 3, v7
    v_lshlrev_b32 v13, 1, v13
    s_add_u32 s62, s47, 0
    v_lshrrev_b32 v13, v13, v6
    v_bfe_u32 v7, v8, 1, 1
    buffer_load_dwordx4 a[0:3], v50, s[12:15], s62 offen offset:0
    v_xor_b32 v13, v13, v7
    v_xor_b32 v13, v13, v9
    s_add_u32 s63, s47, 2304
    v_xor_b32 v13, v13, v4
    v_mul_u32_u24 v7, 9216, v9
    v_mul_u32_u24 v15, 192, v8
    v_and_b32 v13, 3, v13
    v_add_u32 v7, v7, v15
    v_mul_u32_u24_e64 v8, 12, v5
    v_lshl_add_u32 v233, v13, 4, v7
    v_add3_u32 v8, v8, v11, 8
    s_add_u32 s64, s47, 18432
    v_lshrrev_b32 v7, 2, v8
    buffer_load_dwordx4 a[4:7], v50, s[12:15], s62 offen offset:64
    v_and_b32 v13, 3, v7
    v_lshlrev_b32 v13, 1, v13
    v_lshrrev_b32 v13, v13, v6
    v_bfe_u32 v7, v8, 1, 1
    v_xor_b32 v13, v13, v7
    v_xor_b32 v13, v13, v9
    v_xor_b32 v13, v13, v4
    v_mul_u32_u24 v7, 9216, v9
    v_mul_u32_u24 v15, 192, v8
    v_and_b32 v13, 3, v13
    v_add_u32 v7, v7, v15
    v_lshl_add_u32 v234, v13, 4, v7
    v_sub_u32 v6, v11, v4
    buffer_load_dwordx4 a[8:11], v50, s[12:15], s62 offen offset:128
    v_and_b32 v6, 3, v6
    v_mul_u32_u24 v7, 12, v5
    v_lshl_add_u32 v7, v6, 2, v7
    v_add_u32 v7, v7, v4
    v_mul_u32_u24 v15, 48, v9
    v_add_u32_e64 v7, v7, v15
    v_lshl_add_u32 v15, v5, 2, v4
    v_cmp_gt_u32 s[68:69], 12, v15
    v_mul_u32_u24 v15, 2320, v15
    v_lshl_add_u32 v15, v9, 2, v15
    v_cmp_ne_u32 s[44:45], 3, v6
    v_lshlrev_b32_e64 v7, 2, v7
    v_add_u32 v15, 115200, v15
    buffer_load_dwordx4 a[12:15], v50, s[12:15], s63 offen offset:0
    v_cmp_eq_u32 s[32:33], 1, v9
    v_add_u32 v7, 36864, v7
    v_cndmask_b32_e64 v15, v12, v15, s[68:69]
    v_cmp_eq_u32 s[34:35], 2, v9
    v_cmp_eq_u32 s[36:37], 3, v9
    v_cndmask_b32_e64 v235, v15, v7, s[44:45]
    v_cmp_eq_u32 s[68:69], 0, v6
    v_mov_b32 v5, 0x3f80
    v_mov_b32_e64 v8, 0x3f800000
    v_cndmask_b32_e64 v7, v5, v8, s[32:33]
    v_cndmask_b32_e64 v7, v7, 0, s[34:35]
    v_cndmask_b32_e64 v225, 0, -1, s[68:69]
    v_cndmask_b32_e64 v7, v7, 0, s[36:37]
    buffer_load_dwordx4 a[16:19], v50, s[12:15], s63 offen offset:64
    v_and_b32 v252, v7, v225
    v_cndmask_b32_e64 v7, 0, v5, s[34:35]
    v_cndmask_b32_e64 v7, v7, v8, s[36:37]
    v_and_b32 v253, v7, v225
    v_lshrrev_b32 v7, 3, v2
    v_lshlrev_b32 v7, 4, v7
    v_and_b32 v15, 7, v2
    v_add_u32 v7, v7, v15
    v_and_b32 v15, 1, v4
    v_lshl_add_u32 v7, v15, 3, v7
    v_lshrrev_b32 v15, 1, v4
    v_lshl_add_u32 v7, v15, 5, v7
    v_lshlrev_b32 v5, 4, v7
    buffer_load_dwordx4 a[20:23], v50, s[12:15], s63 offen offset:128
    v_lshrrev_b32 v7, 3, v2
    v_lshl_add_u32 v193, v7, 2, v9
    v_and_b32 v7, 1, v4
    s_mov_b32 s48, 93696
    s_cmp_eq_u32 s20, 1
    v_lshl_add_u32 v193, v7, 3, v193
    s_cselect_b32 s48, 112896, s48
    v_lshrrev_b32 v15, 1, v4
    s_cmp_eq_u32 s20, 2
    v_lshlrev_b32_e64 v7, 3, v4
    v_bfe_u32 v14, v2, 2, 1
    v_lshl_add_u32 v193, v15, 5, v193
    s_cselect_b32 s48, 75264, s48
    v_add_u32 v7, v7, v11
    buffer_load_dwordx4 a[24:27], v50, s[12:15], s64 offen offset:0
    v_lshl_add_u32 v193, v14, 6, v193
    s_cmp_eq_u32 s20, 3
    v_mul_u32_u24 v7, 192, v7
    v_lshlrev_b32 v193, 4, v193
    s_cselect_b32 s48, 140736, s48
    v_lshl_add_u32 v7, v9, 3, v7
    v_add_u32 v230, s43, v3
    s_mov_b32 s42, 0
    v_lshl_add_u32 v228, v2, 2, v10
    v_cmp_ne_u32 s[38:39], 1, v6
    v_cmp_ne_u32 s[40:41], 2, v6
    v_mov_b32 v250, 0
    v_mov_b32 v251, 0
    buffer_load_dwordx4 a[28:31], v50, s[12:15], s64 offen offset:64
    v_mov_b32 v254, 0
    v_mov_b32 v255, 0
    v_add_u32 v207, 75264, v5
    v_add_u32 v231, 140736, v5
    v_add_u32 v193, s48, v193
    v_add_u32 v2, s50, v7
    buffer_load_dwordx4 a[32:35], v50, s[12:15], s64 offen offset:128
    s_cmp_lg_u32 s46, 0
    s_mov_b32 s52, 0x41622adf
    s_cselect_b32 s52, 0x411cc471, s52
    s_cselect_b32 s54, 0, 0xbe16c740
    s_waitcnt vmcnt(9)
    s_cbranch_scc0 L_fold_d
    ds_read_b64_tr_b16 a[72:73], v2 offset:0
    ds_read_b64_tr_b16 a[74:75], v2 offset:768
    ds_read_b64_tr_b16 a[76:77], v2 offset:6144
    ds_read_b64_tr_b16 a[78:79], v2 offset:6912
    ds_read_b64_tr_b16 a[80:81], v2 offset:12288
    ds_read_b64_tr_b16 a[82:83], v2 offset:13056
    ds_read_b64_tr_b16 a[84:85], v2 offset:32
    ds_read_b64_tr_b16 a[86:87], v2 offset:800
    ds_read_b64_tr_b16 a[88:89], v2 offset:6176
    ds_read_b64_tr_b16 a[90:91], v2 offset:6944
    ds_read_b64_tr_b16 a[92:93], v2 offset:12320
    ds_read_b64_tr_b16 a[94:95], v2 offset:13088
    ds_read_b64_tr_b16 a[96:97], v2 offset:64
    ds_read_b64_tr_b16 a[98:99], v2 offset:832
    s_waitcnt lgkmcnt(14)
    ds_read_b64_tr_b16 a[100:101], v2 offset:6208
    s_waitcnt lgkmcnt(14)
    ds_read_b64_tr_b16 a[102:103], v2 offset:6976
    s_waitcnt lgkmcnt(14)
    ds_read_b64_tr_b16 a[104:105], v2 offset:12352
    s_waitcnt lgkmcnt(14)
    ds_read_b64_tr_b16 a[106:107], v2 offset:13120
    s_waitcnt lgkmcnt(14)
    ds_read_b64_tr_b16 a[108:109], v2 offset:96
    s_waitcnt lgkmcnt(14)
    ds_read_b64_tr_b16 a[110:111], v2 offset:864
    s_waitcnt lgkmcnt(14)
    ds_read_b64_tr_b16 a[112:113], v2 offset:6240
    s_waitcnt lgkmcnt(14)
    ds_read_b64_tr_b16 a[114:115], v2 offset:7008
    s_waitcnt lgkmcnt(14)
    ds_read_b64_tr_b16 a[116:117], v2 offset:12384
    s_waitcnt lgkmcnt(14)
    ds_read_b64_tr_b16 a[118:119], v2 offset:13152
    s_waitcnt lgkmcnt(14)
    ds_read_b64_tr_b16 a[120:121], v2 offset:128
    s_waitcnt lgkmcnt(14)
    ds_read_b64_tr_b16 a[122:123], v2 offset:896
    s_waitcnt lgkmcnt(14)
    ds_read_b64_tr_b16 a[124:125], v2 offset:6272
    s_waitcnt lgkmcnt(14)
    ds_read_b64_tr_b16 a[126:127], v2 offset:7040
    s_waitcnt lgkmcnt(14)
    ds_read_b64_tr_b16 a[128:129], v2 offset:12416
    s_waitcnt lgkmcnt(14)
    ds_read_b64_tr_b16 a[130:131], v2 offset:13184
    s_waitcnt lgkmcnt(14)
    ds_read_b64_tr_b16 a[132:133], v2 offset:160
    s_waitcnt lgkmcnt(14)
    ds_read_b64_tr_b16 a[134:135], v2 offset:928
    s_waitcnt lgkmcnt(14)
    ds_read_b64_tr_b16 a[136:137], v2 offset:6304
    s_waitcnt lgkmcnt(14)
    ds_read_b64_tr_b16 a[138:139], v2 offset:7072
    s_waitcnt lgkmcnt(14)
    ds_read_b64_tr_b16 a[140:141], v2 offset:12448
    s_waitcnt lgkmcnt(14)
    ds_read_b64_tr_b16 a[142:143], v2 offset:13216
    s_waitcnt lgkmcnt(0)
L_fold_d:
    s_waitcnt vmcnt(8)
    v_mfma_f32_16x16x32_bf16 v[38:41], a[0:3], a[72:75], 0
    s_add_u32 s65, s47, 20736
    buffer_load_dwordx4 a[36:39], v50, s[12:15], s65 offen offset:0
    v_mov_b32 v184, s52
    s_waitcnt vmcnt(8)
    v_mfma_f32_16x16x32_bf16 v[38:41], a[4:7], a[76:79], v[38:41]
    s_add_u32 s66, s47, 36864
    v_mov_b32 v185, s54
    s_add_u32 s67, s47, 39168
    s_waitcnt vmcnt(7)
    v_mfma_f32_16x16x32_bf16 v[38:41], a[8:11], a[80:83], v[38:41]
    s_add_u32 m0, s43, 0
    v_mfma_f32_16x16x32_bf16 v[30:33], a[0:3], a[84:87], 0
    v_mfma_f32_16x16x32_bf16 v[30:33], a[4:7], a[88:91], v[30:33]
    buffer_load_dwordx4 a[40:43], v50, s[12:15], s65 offen offset:64
    v_mfma_f32_16x16x32_bf16 v[30:33], a[8:11], a[92:95], v[30:33]
    v_mfma_f32_16x16x32_bf16 v[22:25], a[0:3], a[96:99], 0
    v_mfma_f32_16x16x32_bf16 v[22:25], a[4:7], a[100:103], v[22:25]
    v_add_f32 v42, v38, v30
    v_add_f32 v43, v39, v31
    v_mfma_f32_16x16x32_bf16 v[22:25], a[8:11], a[104:107], v[22:25]
    buffer_load_dwordx4 a[44:47], v50, s[12:15], s65 offen offset:128
    v_add_f32 v44, v40, v32
    v_mfma_f32_16x16x32_bf16 v[10:13], a[0:3], a[108:111], 0
    v_add_f32 v45, v41, v33
    v_mfma_f32_16x16x32_bf16 v[10:13], a[4:7], a[112:115], v[10:13]
    v_add_f32 v42, v42, v22
    v_add_f32 v43, v43, v23
    v_mfma_f32_16x16x32_bf16 v[10:13], a[8:11], a[116:119], v[10:13]
    v_add_f32 v44, v44, v24
    v_add_f32 v45, v45, v25
    v_mfma_f32_16x16x32_bf16 v[6:9], a[0:3], a[120:123], 0
    buffer_load_dwordx4 a[48:51], v50, s[12:15], s66 offen offset:0
    v_mfma_f32_16x16x32_bf16 v[6:9], a[4:7], a[124:127], v[6:9]
    v_add_f32 v42, v42, v10
    v_add_f32 v43, v43, v11
    v_mfma_f32_16x16x32_bf16 v[6:9], a[8:11], a[128:131], v[6:9]
    v_add_f32 v44, v44, v12
    v_add_f32 v45, v45, v13
    v_mfma_f32_16x16x32_bf16 v[2:5], a[0:3], a[132:135], 0
    v_mfma_f32_16x16x32_bf16 v[2:5], a[4:7], a[136:139], v[2:5]
    v_add_f32 v42, v42, v6
    v_add_f32 v43, v43, v7
    v_mfma_f32_16x16x32_bf16 v[2:5], a[8:11], a[140:143], v[2:5]
    v_add_f32 v44, v44, v8
    v_add_f32 v45, v45, v9
    s_waitcnt vmcnt(9)
    v_mfma_f32_16x16x32_bf16 v[58:61], a[12:15], a[72:75], 0
    buffer_load_dwordx4 a[52:55], v50, s[12:15], s66 offen offset:64
    s_waitcnt vmcnt(9)
    v_mfma_f32_16x16x32_bf16 v[58:61], a[16:19], a[76:79], v[58:61]
    v_add_f32 v42, v42, v2
    v_add_f32 v43, v43, v3
    s_waitcnt vmcnt(8)
    v_mfma_f32_16x16x32_bf16 v[58:61], a[20:23], a[80:83], v[58:61]
    v_add_f32 v44, v44, v4
    v_add_f32 v45, v45, v5
    v_mfma_f32_16x16x32_bf16 v[54:57], a[12:15], a[84:87], 0
    v_add_f32_dpp v42, v42, v42 row_ror:8 row_mask:0xf bank_mask:0xf
    v_add_f32_dpp v43, v43, v43 row_ror:8 row_mask:0xf bank_mask:0xf
    v_mfma_f32_16x16x32_bf16 v[54:57], a[16:19], a[88:91], v[54:57]
    v_add_f32_dpp v44, v44, v44 row_ror:8 row_mask:0xf bank_mask:0xf
    v_add_f32_dpp v45, v45, v45 row_ror:8 row_mask:0xf bank_mask:0xf
    v_mfma_f32_16x16x32_bf16 v[54:57], a[20:23], a[92:95], v[54:57]
    v_add_f32_dpp v42, v42, v42 row_ror:4 row_mask:0xf bank_mask:0xf
    v_add_f32_dpp v43, v43, v43 row_ror:4 row_mask:0xf bank_mask:0xf
    v_mfma_f32_16x16x32_bf16 v[46:49], a[12:15], a[96:99], 0
    buffer_load_dwordx4 a[56:59], v50, s[12:15], s66 offen offset:128
    v_add_f32_dpp v44, v44, v44 row_ror:4 row_mask:0xf bank_mask:0xf
    v_mfma_f32_16x16x32_bf16 v[46:49], a[16:19], a[100:103], v[46:49]
    v_add_f32 v74, v58, v54
    v_add_f32 v75, v59, v55
    v_mfma_f32_16x16x32_bf16 v[46:49], a[20:23], a[104:107], v[46:49]
    v_add_f32 v76, v60, v56
    v_add_f32 v77, v61, v57
    v_mfma_f32_16x16x32_bf16 v[34:37], a[12:15], a[108:111], 0
    v_add_f32_dpp v45, v45, v45 row_ror:4 row_mask:0xf bank_mask:0xf
    v_add_f32_dpp v42, v42, v42 row_ror:2 row_mask:0xf bank_mask:0xf
    v_mfma_f32_16x16x32_bf16 v[34:37], a[16:19], a[112:115], v[34:37]
    v_add_f32 v74, v74, v46
    v_add_f32 v75, v75, v47
    v_mfma_f32_16x16x32_bf16 v[34:37], a[20:23], a[116:119], v[34:37]
    v_add_f32 v76, v76, v48
    v_add_f32 v77, v77, v49
    v_mfma_f32_16x16x32_bf16 v[26:29], a[12:15], a[120:123], 0
    buffer_load_dwordx4 a[60:63], v50, s[12:15], s67 offen offset:0
    v_add_f32_dpp v43, v43, v43 row_ror:2 row_mask:0xf bank_mask:0xf
    v_mfma_f32_16x16x32_bf16 v[26:29], a[16:19], a[124:127], v[26:29]
    v_add_f32 v74, v74, v34
    v_add_f32 v75, v75, v35
    v_mfma_f32_16x16x32_bf16 v[26:29], a[20:23], a[128:131], v[26:29]
    v_add_f32 v76, v76, v36
    v_add_f32 v77, v77, v37
    v_mfma_f32_16x16x32_bf16 v[14:17], a[12:15], a[132:135], 0
    v_add_f32_dpp v44, v44, v44 row_ror:2 row_mask:0xf bank_mask:0xf
    v_add_f32_dpp v45, v45, v45 row_ror:2 row_mask:0xf bank_mask:0xf
    v_mfma_f32_16x16x32_bf16 v[14:17], a[16:19], a[136:139], v[14:17]
    v_add_f32 v74, v74, v26
    v_add_f32 v75, v75, v27
    v_mfma_f32_16x16x32_bf16 v[14:17], a[20:23], a[140:143], v[14:17]
    v_add_f32 v76, v76, v28
    v_add_f32 v77, v77, v29
    v_add_f32_dpp v42, v42, v42 row_ror:1 row_mask:0xf bank_mask:0xf
    v_add_f32_dpp v43, v43, v43 row_ror:1 row_mask:0xf bank_mask:0xf
    v_add_f32_dpp v44, v44, v44 row_ror:1 row_mask:0xf bank_mask:0xf
    v_add_f32_dpp v45, v45, v45 row_ror:1 row_mask:0xf bank_mask:0xf
    v_pk_mul_f32 v[18:19], v[42:43], v[184:185] op_sel_hi:[1,0]
    v_add_f32 v74, v74, v14
    v_add_f32 v75, v75, v15
    v_add_f32 v76, v76, v16
    v_add_f32 v77, v77, v17
    v_add_f32_dpp v74, v74, v74 row_ror:8 row_mask:0xf bank_mask:0xf
    v_add_f32_dpp v75, v75, v75 row_ror:8 row_mask:0xf bank_mask:0xf
    v_add_f32_dpp v76, v76, v76 row_ror:8 row_mask:0xf bank_mask:0xf
    v_add_f32_dpp v77, v77, v77 row_ror:8 row_mask:0xf bank_mask:0xf
    v_add_f32_dpp v74, v74, v74 row_ror:4 row_mask:0xf bank_mask:0xf
    v_add_f32_dpp v75, v75, v75 row_ror:4 row_mask:0xf bank_mask:0xf
    v_add_f32_dpp v76, v76, v76 row_ror:4 row_mask:0xf bank_mask:0xf
    v_add_f32_dpp v77, v77, v77 row_ror:4 row_mask:0xf bank_mask:0xf
    v_add_f32_dpp v74, v74, v74 row_ror:2 row_mask:0xf bank_mask:0xf
    v_add_f32_dpp v75, v75, v75 row_ror:2 row_mask:0xf bank_mask:0xf
    v_add_f32_dpp v76, v76, v76 row_ror:2 row_mask:0xf bank_mask:0xf
    v_add_f32_dpp v77, v77, v77 row_ror:2 row_mask:0xf bank_mask:0xf
    v_add_f32_dpp v74, v74, v74 row_ror:1 row_mask:0xf bank_mask:0xf
    v_add_f32_dpp v75, v75, v75 row_ror:1 row_mask:0xf bank_mask:0xf
    v_pk_mul_f32 v[20:21], v[44:45], v[184:185] op_sel_hi:[1,0]
    v_add_f32_dpp v76, v76, v76 row_ror:1 row_mask:0xf bank_mask:0xf
    v_add_f32_dpp v77, v77, v77 row_ror:1 row_mask:0xf bank_mask:0xf
    v_pk_mul_f32 v[42:43], v[42:43], v[184:185] op_sel:[0,1] op_sel_hi:[1,1]
    v_pk_mul_f32 v[44:45], v[44:45], v[184:185] op_sel:[0,1] op_sel_hi:[1,1]
    v_pk_fma_f32 v[38:39], v[38:39], v[184:185], v[42:43] op_sel_hi:[1,0,1]
    v_pk_fma_f32 v[40:41], v[40:41], v[184:185], v[44:45] op_sel_hi:[1,0,1]
    v_pk_fma_f32 v[30:31], v[30:31], v[184:185], v[42:43] op_sel_hi:[1,0,1]
    v_pk_fma_f32 v[32:33], v[32:33], v[184:185], v[44:45] op_sel_hi:[1,0,1]
    v_pk_add_f32 v[190:191], v[38:39], v[40:41]
    v_pk_add_f32 v[188:189], v[30:31], v[32:33]
    v_pk_fma_f32 v[22:23], v[22:23], v[184:185], v[42:43] op_sel_hi:[1,0,1]
    v_pk_fma_f32 v[24:25], v[24:25], v[184:185], v[44:45] op_sel_hi:[1,0,1]
    v_pk_add_f32 v[186:187], v[22:23], v[24:25]
    v_pk_fma_f32 v[10:11], v[10:11], v[184:185], v[42:43] op_sel_hi:[1,0,1]
    v_pk_fma_f32 v[12:13], v[12:13], v[184:185], v[44:45] op_sel_hi:[1,0,1]
    v_pk_add_f32 v[182:183], v[10:11], v[12:13]
    v_pk_fma_f32 v[6:7], v[6:7], v[184:185], v[42:43] op_sel_hi:[1,0,1]
    v_pk_fma_f32 v[8:9], v[8:9], v[184:185], v[44:45] op_sel_hi:[1,0,1]
    v_pk_add_f32 v[180:181], v[6:7], v[8:9]
    v_pk_fma_f32 v[2:3], v[2:3], v[184:185], v[42:43] op_sel_hi:[1,0,1]
    v_pk_fma_f32 v[4:5], v[4:5], v[184:185], v[44:45] op_sel_hi:[1,0,1]
    v_pk_add_f32 v[178:179], v[2:3], v[4:5]
    s_waitcnt vmcnt(9)
    v_mfma_f32_16x16x32_bf16 v[86:89], a[24:27], a[72:75], 0
    buffer_load_dwordx4 a[64:67], v50, s[12:15], s67 offen offset:64
    s_waitcnt vmcnt(9)
    v_mfma_f32_16x16x32_bf16 v[86:89], a[28:31], a[76:79], v[86:89]
    s_waitcnt vmcnt(8)
    v_mfma_f32_16x16x32_bf16 v[86:89], a[32:35], a[80:83], v[86:89]
    v_mfma_f32_16x16x32_bf16 v[78:81], a[24:27], a[84:87], 0
    v_mfma_f32_16x16x32_bf16 v[78:81], a[28:31], a[88:91], v[78:81]
    v_mfma_f32_16x16x32_bf16 v[78:81], a[32:35], a[92:95], v[78:81]
    v_mfma_f32_16x16x32_bf16 v[70:73], a[24:27], a[96:99], 0
    buffer_load_dwordx4 a[68:71], v50, s[12:15], s67 offen offset:128
    v_mfma_f32_16x16x32_bf16 v[70:73], a[28:31], a[100:103], v[70:73]
    v_add_f32 v98, v86, v78
    v_add_f32 v99, v87, v79
    v_mfma_f32_16x16x32_bf16 v[70:73], a[32:35], a[104:107], v[70:73]
    v_add_f32 v100, v88, v80
    v_add_f32 v101, v89, v81
    v_mfma_f32_16x16x32_bf16 v[66:69], a[24:27], a[108:111], 0
    v_mfma_f32_16x16x32_bf16 v[66:69], a[28:31], a[112:115], v[66:69]
    v_add_f32 v98, v98, v70
    v_add_f32 v99, v99, v71
    v_mfma_f32_16x16x32_bf16 v[66:69], a[32:35], a[116:119], v[66:69]
    v_add_f32 v100, v100, v72
    v_add_f32 v101, v101, v73
    v_mfma_f32_16x16x32_bf16 v[62:65], a[24:27], a[120:123], 0
    v_mfma_f32_16x16x32_bf16 v[62:65], a[28:31], a[124:127], v[62:65]
    v_add_f32 v98, v98, v66
    v_add_f32 v99, v99, v67
    v_mfma_f32_16x16x32_bf16 v[62:65], a[32:35], a[128:131], v[62:65]
    v_add_f32 v100, v100, v68
    v_add_f32 v101, v101, v69
    v_mfma_f32_16x16x32_bf16 v[42:45], a[24:27], a[132:135], 0
    v_mfma_f32_16x16x32_bf16 v[42:45], a[28:31], a[136:139], v[42:45]
    v_add_f32 v98, v98, v62
    v_add_f32 v99, v99, v63
    v_mfma_f32_16x16x32_bf16 v[42:45], a[32:35], a[140:143], v[42:45]
    v_add_f32 v100, v100, v64
    v_add_f32_e64 v101, v101, v65
    v_pk_mul_f32 v[50:51], v[74:75], v[184:185] op_sel_hi:[1,0]
    v_pk_mul_f32 v[52:53], v[76:77], v[184:185] op_sel_hi:[1,0]
    v_pk_mul_f32 v[74:75], v[74:75], v[184:185] op_sel:[0,1] op_sel_hi:[1,1]
    v_pk_mul_f32 v[76:77], v[76:77], v[184:185] op_sel:[0,1] op_sel_hi:[1,1]
    v_pk_fma_f32 v[58:59], v[58:59], v[184:185], v[74:75] op_sel_hi:[1,0,1]
    v_add_f32 v98, v98, v42
    v_add_f32 v99, v99, v43
    v_add_f32 v100, v100, v44
    v_add_f32 v101, v101, v45
    v_add_f32_dpp v98, v98, v98 row_ror:8 row_mask:0xf bank_mask:0xf
    v_add_f32_dpp v99, v99, v99 row_ror:8 row_mask:0xf bank_mask:0xf
    v_add_f32_dpp v100, v100, v100 row_ror:8 row_mask:0xf bank_mask:0xf
    v_add_f32_dpp v101, v101, v101 row_ror:8 row_mask:0xf bank_mask:0xf
    v_add_f32_dpp v98, v98, v98 row_ror:4 row_mask:0xf bank_mask:0xf
    v_add_f32_dpp v99, v99, v99 row_ror:4 row_mask:0xf bank_mask:0xf
    v_add_f32_dpp v100, v100, v100 row_ror:4 row_mask:0xf bank_mask:0xf
    v_add_f32_dpp v101, v101, v101 row_ror:4 row_mask:0xf bank_mask:0xf
    v_add_f32_dpp v98, v98, v98 row_ror:2 row_mask:0xf bank_mask:0xf
    v_add_f32_dpp v99, v99, v99 row_ror:2 row_mask:0xf bank_mask:0xf
    v_add_f32_dpp v100, v100, v100 row_ror:2 row_mask:0xf bank_mask:0xf
    v_add_f32_dpp v101, v101, v101 row_ror:2 row_mask:0xf bank_mask:0xf
    v_add_f32_dpp v98, v98, v98 row_ror:1 row_mask:0xf bank_mask:0xf
    v_add_f32_dpp v99, v99, v99 row_ror:1 row_mask:0xf bank_mask:0xf
    v_add_f32_dpp v100, v100, v100 row_ror:1 row_mask:0xf bank_mask:0xf
    v_add_f32_dpp v101, v101, v101 row_ror:1 row_mask:0xf bank_mask:0xf
    v_pk_fma_f32 v[54:55], v[54:55], v[184:185], v[74:75] op_sel_hi:[1,0,1]
    v_pk_fma_f32 v[60:61], v[60:61], v[184:185], v[76:77] op_sel_hi:[1,0,1]
    v_pk_add_f32 v[190:191], v[190:191], v[58:59]
    v_pk_fma_f32 v[56:57], v[56:57], v[184:185], v[76:77] op_sel_hi:[1,0,1]
    v_pk_add_f32 v[188:189], v[188:189], v[54:55]
    v_pk_fma_f32 v[46:47], v[46:47], v[184:185], v[74:75] op_sel_hi:[1,0,1]
    v_pk_add_f32 v[190:191], v[190:191], v[60:61]
    v_pk_add_f32 v[188:189], v[188:189], v[56:57]
    v_pk_fma_f32 v[48:49], v[48:49], v[184:185], v[76:77] op_sel_hi:[1,0,1]
    v_pk_add_f32 v[186:187], v[186:187], v[46:47]
    v_pk_fma_f32 v[34:35], v[34:35], v[184:185], v[74:75] op_sel_hi:[1,0,1]
    v_pk_add_f32 v[186:187], v[186:187], v[48:49]
    v_pk_fma_f32 v[36:37], v[36:37], v[184:185], v[76:77] op_sel_hi:[1,0,1]
    v_pk_add_f32 v[182:183], v[182:183], v[34:35]
    v_pk_fma_f32 v[26:27], v[26:27], v[184:185], v[74:75] op_sel_hi:[1,0,1]
    v_pk_add_f32 v[182:183], v[182:183], v[36:37]
    v_pk_fma_f32 v[28:29], v[28:29], v[184:185], v[76:77] op_sel_hi:[1,0,1]
    v_pk_add_f32 v[180:181], v[180:181], v[26:27]
    v_pk_fma_f32 v[14:15], v[14:15], v[184:185], v[74:75] op_sel_hi:[1,0,1]
    v_pk_add_f32 v[180:181], v[180:181], v[28:29]
    v_pk_fma_f32 v[16:17], v[16:17], v[184:185], v[76:77] op_sel_hi:[1,0,1]
    v_pk_add_f32 v[178:179], v[178:179], v[14:15]
    v_pk_add_f32 v[178:179], v[178:179], v[16:17]
    s_waitcnt vmcnt(8)
    v_mfma_f32_16x16x32_bf16 v[114:117], a[36:39], a[72:75], 0
    buffer_load_dwordx4 v212, s[4:7], s26 offen nt lds
    s_add_u32 m0, s43, 1024
    s_waitcnt vmcnt(8)
    v_mfma_f32_16x16x32_bf16 v[114:117], a[40:43], a[76:79], v[114:117]
    s_waitcnt vmcnt(7)
    v_mfma_f32_16x16x32_bf16 v[114:117], a[44:47], a[80:83], v[114:117]
    v_mfma_f32_16x16x32_bf16 v[106:109], a[36:39], a[84:87], 0
    v_mfma_f32_16x16x32_bf16 v[106:109], a[40:43], a[88:91], v[106:109]
    buffer_load_dwordx4 v213, s[4:7], s26 offen nt lds
    s_add_u32 m0, s43, 2048
    v_mfma_f32_16x16x32_bf16 v[106:109], a[44:47], a[92:95], v[106:109]
    v_mfma_f32_16x16x32_bf16 v[102:105], a[36:39], a[96:99], 0
    v_mfma_f32_16x16x32_bf16 v[102:105], a[40:43], a[100:103], v[102:105]
    v_add_f32 v126, v114, v106
    v_add_f32 v127, v115, v107
    v_mfma_f32_16x16x32_bf16 v[102:105], a[44:47], a[104:107], v[102:105]
    buffer_load_dwordx4 v214, s[4:7], s26 offen nt lds
    v_add_f32 v128, v116, v108
    v_mfma_f32_16x16x32_bf16 v[94:97], a[36:39], a[108:111], 0
    s_add_u32 m0, s43, 3072
    v_add_f32 v129, v117, v109
    v_mfma_f32_16x16x32_bf16 v[94:97], a[40:43], a[112:115], v[94:97]
    v_add_f32 v126, v126, v102
    v_add_f32 v127, v127, v103
    v_mfma_f32_16x16x32_bf16 v[94:97], a[44:47], a[116:119], v[94:97]
    v_add_f32 v128, v128, v104
    v_add_f32 v129, v129, v105
    v_mfma_f32_16x16x32_bf16 v[90:93], a[36:39], a[120:123], 0
    buffer_load_dwordx4 v215, s[4:7], s26 offen nt lds
    s_add_u32 m0, s43, 4096
    v_mfma_f32_16x16x32_bf16 v[90:93], a[40:43], a[124:127], v[90:93]
    v_add_f32 v126, v126, v94
    v_add_f32 v127, v127, v95
    v_mfma_f32_16x16x32_bf16 v[90:93], a[44:47], a[128:131], v[90:93]
    v_add_f32 v128, v128, v96
    v_add_f32 v129, v129, v97
    v_mfma_f32_16x16x32_bf16 v[74:77], a[36:39], a[132:135], 0
    v_mfma_f32_16x16x32_bf16 v[74:77], a[40:43], a[136:139], v[74:77]
    buffer_load_dwordx4 v216, s[4:7], s26 offen nt lds
    v_add_f32 v126, v126, v90
    v_mfma_f32_16x16x32_bf16 v[74:77], a[44:47], a[140:143], v[74:77]
    s_add_u32 m0, s43, 5120
    v_add_f32 v127, v127, v91
    v_add_f32 v128, v128, v92
    v_add_f32_e64 v129, v129, v93
    v_pk_mul_f32 v[82:83], v[98:99], v[184:185] op_sel_hi:[1,0]
    v_pk_mul_f32 v[84:85], v[100:101], v[184:185] op_sel_hi:[1,0]
    v_pk_mul_f32 v[98:99], v[98:99], v[184:185] op_sel:[0,1] op_sel_hi:[1,1]
    v_pk_mul_f32 v[100:101], v[100:101], v[184:185] op_sel:[0,1] op_sel_hi:[1,1]
    v_add_f32 v126, v126, v74
    v_add_f32 v127, v127, v75
    v_add_f32 v128, v128, v76
    v_add_f32 v129, v129, v77
    v_add_f32_dpp v126, v126, v126 row_ror:8 row_mask:0xf bank_mask:0xf
    v_add_f32_dpp v127, v127, v127 row_ror:8 row_mask:0xf bank_mask:0xf
    v_add_f32_dpp v128, v128, v128 row_ror:8 row_mask:0xf bank_mask:0xf
    v_add_f32_dpp v129, v129, v129 row_ror:8 row_mask:0xf bank_mask:0xf
    v_add_f32_dpp v126, v126, v126 row_ror:4 row_mask:0xf bank_mask:0xf
    v_add_f32_dpp v127, v127, v127 row_ror:4 row_mask:0xf bank_mask:0xf
    v_add_f32_dpp v128, v128, v128 row_ror:4 row_mask:0xf bank_mask:0xf
    v_add_f32_dpp v129, v129, v129 row_ror:4 row_mask:0xf bank_mask:0xf
    v_add_f32_dpp v126, v126, v126 row_ror:2 row_mask:0xf bank_mask:0xf
    v_add_f32_dpp v127, v127, v127 row_ror:2 row_mask:0xf bank_mask:0xf
    v_add_f32_dpp v128, v128, v128 row_ror:2 row_mask:0xf bank_mask:0xf
    v_add_f32_dpp v129, v129, v129 row_ror:2 row_mask:0xf bank_mask:0xf
    v_add_f32_dpp v126, v126, v126 row_ror:1 row_mask:0xf bank_mask:0xf
    v_add_f32_dpp v127, v127, v127 row_ror:1 row_mask:0xf bank_mask:0xf
    v_add_f32_dpp v128, v128, v128 row_ror:1 row_mask:0xf bank_mask:0xf
    v_add_f32_dpp v129, v129, v129 row_ror:1 row_mask:0xf bank_mask:0xf
    v_pk_fma_f32 v[86:87], v[86:87], v[184:185], v[98:99] op_sel_hi:[1,0,1]
    v_pk_fma_f32 v[78:79], v[78:79], v[184:185], v[98:99] op_sel_hi:[1,0,1]
    v_pk_fma_f32 v[88:89], v[88:89], v[184:185], v[100:101] op_sel_hi:[1,0,1]
    v_pk_add_f32 v[190:191], v[190:191], v[86:87]
    v_pk_fma_f32 v[80:81], v[80:81], v[184:185], v[100:101] op_sel_hi:[1,0,1]
    v_pk_add_f32 v[188:189], v[188:189], v[78:79]
    v_pk_fma_f32 v[70:71], v[70:71], v[184:185], v[98:99] op_sel_hi:[1,0,1]
    v_pk_add_f32 v[190:191], v[190:191], v[88:89]
    v_pk_add_f32 v[188:189], v[188:189], v[80:81]
    v_pk_fma_f32 v[72:73], v[72:73], v[184:185], v[100:101] op_sel_hi:[1,0,1]
    v_pk_add_f32 v[186:187], v[186:187], v[70:71]
    v_pk_fma_f32 v[66:67], v[66:67], v[184:185], v[98:99] op_sel_hi:[1,0,1]
    v_pk_add_f32 v[186:187], v[186:187], v[72:73]
    v_pk_fma_f32 v[68:69], v[68:69], v[184:185], v[100:101] op_sel_hi:[1,0,1]
    v_pk_add_f32 v[182:183], v[182:183], v[66:67]
    v_pk_fma_f32 v[62:63], v[62:63], v[184:185], v[98:99] op_sel_hi:[1,0,1]
    v_pk_add_f32 v[182:183], v[182:183], v[68:69]
    v_pk_fma_f32 v[64:65], v[64:65], v[184:185], v[100:101] op_sel_hi:[1,0,1]
    v_pk_add_f32 v[180:181], v[180:181], v[62:63]
    v_pk_fma_f32 v[42:43], v[42:43], v[184:185], v[98:99] op_sel_hi:[1,0,1]
    v_pk_add_f32 v[180:181], v[180:181], v[64:65]
    v_pk_fma_f32 v[44:45], v[44:45], v[184:185], v[100:101] op_sel_hi:[1,0,1]
    v_pk_add_f32 v[178:179], v[178:179], v[42:43]
    v_pk_add_f32 v[178:179], v[178:179], v[44:45]
    s_waitcnt vmcnt(10)
    v_mfma_f32_16x16x32_bf16 v[142:145], a[48:51], a[72:75], 0
    buffer_load_dwordx4 v217, s[4:7], s26 offen nt lds
    s_add_u32 m0, s43, 6144
    s_waitcnt vmcnt(10)
    v_mfma_f32_16x16x32_bf16 v[142:145], a[52:55], a[76:79], v[142:145]
    s_waitcnt vmcnt(9)
    v_mfma_f32_16x16x32_bf16 v[142:145], a[56:59], a[80:83], v[142:145]
    v_mfma_f32_16x16x32_bf16 v[134:137], a[48:51], a[84:87], 0
    v_mfma_f32_16x16x32_bf16 v[134:137], a[52:55], a[88:91], v[134:137]
    buffer_load_dwordx4 v218, s[4:7], s26 offen nt lds
    s_add_u32 m0, s43, 7168
    v_mfma_f32_16x16x32_bf16 v[134:137], a[56:59], a[92:95], v[134:137]
    v_mfma_f32_16x16x32_bf16 v[130:133], a[48:51], a[96:99], 0
    v_mfma_f32_16x16x32_bf16 v[130:133], a[52:55], a[100:103], v[130:133]
    v_add_f32 v170, v142, v134
    v_add_f32 v171, v143, v135
    v_mfma_f32_16x16x32_bf16 v[130:133], a[56:59], a[104:107], v[130:133]
    buffer_load_dwordx4 v219, s[4:7], s26 offen nt lds
    v_add_f32 v172, v144, v136
    v_mfma_f32_16x16x32_bf16 v[122:125], a[48:51], a[108:111], 0
    s_add_u32 m0, s43, 8192
    v_add_f32 v173, v145, v137
    v_mfma_f32_16x16x32_bf16 v[122:125], a[52:55], a[112:115], v[122:125]
    v_add_f32 v170, v170, v130
    v_add_f32 v171, v171, v131
    v_mfma_f32_16x16x32_bf16 v[122:125], a[56:59], a[116:119], v[122:125]
    v_add_f32 v172, v172, v132
    v_add_f32 v173, v173, v133
    v_mfma_f32_16x16x32_bf16 v[118:121], a[48:51], a[120:123], 0
    buffer_load_dwordx4 v220, s[4:7], s26 offen nt lds
    v_mfma_f32_16x16x32_bf16 v[118:121], a[52:55], a[124:127], v[118:121]
    v_add_f32 v170, v170, v122
    v_add_f32 v171, v171, v123
    v_mfma_f32_16x16x32_bf16 v[118:121], a[56:59], a[128:131], v[118:121]
    v_add_f32 v172, v172, v124
    v_add_f32 v173, v173, v125
    v_mfma_f32_16x16x32_bf16 v[98:101], a[48:51], a[132:135], 0
    v_mfma_f32_16x16x32_bf16 v[98:101], a[52:55], a[136:139], v[98:101]
    buffer_load_dwordx4 a[144:147], v138, s[4:7], 0 offen offset:0 nt
    v_add_f32 v170, v170, v118
    v_mfma_f32_16x16x32_bf16 v[98:101], a[56:59], a[140:143], v[98:101]
    v_add_f32 v171, v171, v119
    v_add_f32 v172, v172, v120
    v_add_f32_e64 v173, v173, v121
    v_pk_mul_f32 v[110:111], v[126:127], v[184:185] op_sel_hi:[1,0]
    v_pk_mul_f32 v[112:113], v[128:129], v[184:185] op_sel_hi:[1,0]
    v_pk_mul_f32 v[126:127], v[126:127], v[184:185] op_sel:[0,1] op_sel_hi:[1,1]
    v_pk_mul_f32 v[128:129], v[128:129], v[184:185] op_sel:[0,1] op_sel_hi:[1,1]
    v_add_f32 v170, v170, v98
    v_add_f32 v171, v171, v99
    v_add_f32 v172, v172, v100
    v_add_f32 v173, v173, v101
    v_add_f32_dpp v170, v170, v170 row_ror:8 row_mask:0xf bank_mask:0xf
    v_add_f32_dpp v171, v171, v171 row_ror:8 row_mask:0xf bank_mask:0xf
    v_add_f32_dpp v172, v172, v172 row_ror:8 row_mask:0xf bank_mask:0xf
    v_add_f32_dpp v173, v173, v173 row_ror:8 row_mask:0xf bank_mask:0xf
    v_add_f32_dpp v170, v170, v170 row_ror:4 row_mask:0xf bank_mask:0xf
    v_add_f32_dpp v171, v171, v171 row_ror:4 row_mask:0xf bank_mask:0xf
    v_add_f32_dpp v172, v172, v172 row_ror:4 row_mask:0xf bank_mask:0xf
    v_add_f32_dpp v173, v173, v173 row_ror:4 row_mask:0xf bank_mask:0xf
    v_add_f32_dpp v170, v170, v170 row_ror:2 row_mask:0xf bank_mask:0xf
    v_add_f32_dpp v171, v171, v171 row_ror:2 row_mask:0xf bank_mask:0xf
    v_add_f32_dpp v172, v172, v172 row_ror:2 row_mask:0xf bank_mask:0xf
    v_add_f32_dpp v173, v173, v173 row_ror:2 row_mask:0xf bank_mask:0xf
    v_add_f32_dpp v170, v170, v170 row_ror:1 row_mask:0xf bank_mask:0xf
    v_add_f32_dpp v171, v171, v171 row_ror:1 row_mask:0xf bank_mask:0xf
    v_add_f32_dpp v172, v172, v172 row_ror:1 row_mask:0xf bank_mask:0xf
    v_add_f32_dpp v173, v173, v173 row_ror:1 row_mask:0xf bank_mask:0xf
    v_pk_fma_f32 v[114:115], v[114:115], v[184:185], v[126:127] op_sel_hi:[1,0,1]
    v_pk_fma_f32 v[106:107], v[106:107], v[184:185], v[126:127] op_sel_hi:[1,0,1]
    v_pk_fma_f32 v[116:117], v[116:117], v[184:185], v[128:129] op_sel_hi:[1,0,1]
    v_pk_add_f32 v[190:191], v[190:191], v[114:115]
    v_pk_fma_f32 v[108:109], v[108:109], v[184:185], v[128:129] op_sel_hi:[1,0,1]
    v_pk_add_f32 v[188:189], v[188:189], v[106:107]
    v_pk_fma_f32 v[102:103], v[102:103], v[184:185], v[126:127] op_sel_hi:[1,0,1]
    v_pk_add_f32 v[190:191], v[190:191], v[116:117]
    v_pk_add_f32 v[188:189], v[188:189], v[108:109]
    v_pk_fma_f32 v[104:105], v[104:105], v[184:185], v[128:129] op_sel_hi:[1,0,1]
    v_pk_add_f32 v[186:187], v[186:187], v[102:103]
    v_pk_fma_f32 v[94:95], v[94:95], v[184:185], v[126:127] op_sel_hi:[1,0,1]
    v_pk_add_f32 v[186:187], v[186:187], v[104:105]
    v_pk_fma_f32 v[96:97], v[96:97], v[184:185], v[128:129] op_sel_hi:[1,0,1]
    v_pk_add_f32 v[182:183], v[182:183], v[94:95]
    v_pk_fma_f32 v[90:91], v[90:91], v[184:185], v[126:127] op_sel_hi:[1,0,1]
    v_pk_add_f32 v[182:183], v[182:183], v[96:97]
    v_pk_fma_f32 v[92:93], v[92:93], v[184:185], v[128:129] op_sel_hi:[1,0,1]
    v_pk_add_f32 v[180:181], v[180:181], v[90:91]
    v_pk_fma_f32 v[74:75], v[74:75], v[184:185], v[126:127] op_sel_hi:[1,0,1]
    v_pk_add_f32 v[180:181], v[180:181], v[92:93]
    v_pk_fma_f32 v[76:77], v[76:77], v[184:185], v[128:129] op_sel_hi:[1,0,1]
    v_pk_add_f32 v[178:179], v[178:179], v[74:75]
    v_pk_add_f32 v[178:179], v[178:179], v[76:77]
    s_waitcnt vmcnt(12)
    v_mfma_f32_16x16x32_bf16 v[166:169], a[60:63], a[72:75], 0
    buffer_load_dwordx4 a[148:151], v138, s[4:7], 0 offen offset:64 nt
    s_waitcnt vmcnt(12)
    v_mfma_f32_16x16x32_bf16 v[166:169], a[64:67], a[76:79], v[166:169]
    s_waitcnt vmcnt(11)
    v_mfma_f32_16x16x32_bf16 v[166:169], a[68:71], a[80:83], v[166:169]
    v_mfma_f32_16x16x32_bf16 v[162:165], a[60:63], a[84:87], 0
    v_mfma_f32_16x16x32_bf16 v[162:165], a[64:67], a[88:91], v[162:165]
    buffer_load_dwordx4 a[152:155], v138, s[4:7], 0 offen offset:128 nt
    v_mfma_f32_16x16x32_bf16 v[162:165], a[68:71], a[92:95], v[162:165]
    v_mfma_f32_16x16x32_bf16 v[158:161], a[60:63], a[96:99], 0
    v_mfma_f32_16x16x32_bf16 v[158:161], a[64:67], a[100:103], v[158:161]
    v_add_f32 v174, v166, v162
    v_add_f32 v175, v167, v163
    v_mfma_f32_16x16x32_bf16 v[158:161], a[68:71], a[104:107], v[158:161]
    v_add_f32 v176, v168, v164
    v_add_f32 v177, v169, v165
    v_mfma_f32_16x16x32_bf16 v[154:157], a[60:63], a[108:111], 0
    v_mfma_f32_16x16x32_bf16 v[154:157], a[64:67], a[112:115], v[154:157]
    v_add_f32 v174, v174, v158
    v_add_f32 v175, v175, v159
    v_mfma_f32_16x16x32_bf16 v[154:157], a[68:71], a[116:119], v[154:157]
    v_add_f32 v176, v176, v160
    v_add_f32 v177, v177, v161
    v_mfma_f32_16x16x32_bf16 v[146:149], a[60:63], a[120:123], 0
    v_mfma_f32_16x16x32_bf16 v[146:149], a[64:67], a[124:127], v[146:149]
    v_add_f32 v174, v174, v154
    v_add_f32 v175, v175, v155
    v_mfma_f32_16x16x32_bf16 v[146:149], a[68:71], a[128:131], v[146:149]
    v_add_f32 v176, v176, v156
    v_add_f32 v177, v177, v157
    v_mfma_f32_16x16x32_bf16 v[126:129], a[60:63], a[132:135], 0
    v_mfma_f32_16x16x32_bf16 v[126:129], a[64:67], a[136:139], v[126:129]
    v_add_f32 v174, v174, v146
    v_add_f32 v175, v175, v147
    v_mfma_f32_16x16x32_bf16 v[126:129], a[68:71], a[140:143], v[126:129]
    v_add_f32 v176, v176, v148
    v_add_f32_e64 v177, v177, v149
    v_pk_mul_f32 v[138:139], v[170:171], v[184:185] op_sel_hi:[1,0]
    v_pk_mul_f32 v[140:141], v[172:173], v[184:185] op_sel_hi:[1,0]
    v_pk_mul_f32 v[170:171], v[170:171], v[184:185] op_sel:[0,1] op_sel_hi:[1,1]
    v_pk_mul_f32 v[172:173], v[172:173], v[184:185] op_sel:[0,1] op_sel_hi:[1,1]
    v_pk_fma_f32 v[142:143], v[142:143], v[184:185], v[170:171] op_sel_hi:[1,0,1]
    v_add_f32 v174, v174, v126
    v_add_f32 v175, v175, v127
    v_add_f32 v176, v176, v128
    v_add_f32 v177, v177, v129
    v_add_f32_dpp v174, v174, v174 row_ror:8 row_mask:0xf bank_mask:0xf
    v_add_f32_dpp v175, v175, v175 row_ror:8 row_mask:0xf bank_mask:0xf
    v_add_f32_dpp v176, v176, v176 row_ror:8 row_mask:0xf bank_mask:0xf
    v_add_f32_dpp v177, v177, v177 row_ror:8 row_mask:0xf bank_mask:0xf
    v_add_f32_dpp v174, v174, v174 row_ror:4 row_mask:0xf bank_mask:0xf
    v_add_f32_dpp v175, v175, v175 row_ror:4 row_mask:0xf bank_mask:0xf
    v_add_f32_dpp v176, v176, v176 row_ror:4 row_mask:0xf bank_mask:0xf
    v_add_f32_dpp v177, v177, v177 row_ror:4 row_mask:0xf bank_mask:0xf
    v_add_f32_dpp v174, v174, v174 row_ror:2 row_mask:0xf bank_mask:0xf
    v_add_f32_dpp v175, v175, v175 row_ror:2 row_mask:0xf bank_mask:0xf
    v_add_f32_dpp v176, v176, v176 row_ror:2 row_mask:0xf bank_mask:0xf
    v_add_f32_dpp v177, v177, v177 row_ror:2 row_mask:0xf bank_mask:0xf
    v_add_f32_dpp v174, v174, v174 row_ror:1 row_mask:0xf bank_mask:0xf
    v_add_f32_dpp v175, v175, v175 row_ror:1 row_mask:0xf bank_mask:0xf
    v_add_f32_dpp v176, v176, v176 row_ror:1 row_mask:0xf bank_mask:0xf
    v_add_f32_dpp v177, v177, v177 row_ror:1 row_mask:0xf bank_mask:0xf
    v_pk_fma_f32 v[134:135], v[134:135], v[184:185], v[170:171] op_sel_hi:[1,0,1]
    v_pk_mul_f32 v[150:151], v[174:175], v[184:185] op_sel_hi:[1,0]
    v_pk_fma_f32 v[144:145], v[144:145], v[184:185], v[172:173] op_sel_hi:[1,0,1]
    v_pk_add_f32 v[190:191], v[190:191], v[142:143]
    v_pk_fma_f32 v[136:137], v[136:137], v[184:185], v[172:173] op_sel_hi:[1,0,1]
    v_pk_add_f32 v[188:189], v[188:189], v[134:135]
    v_pk_fma_f32 v[130:131], v[130:131], v[184:185], v[170:171] op_sel_hi:[1,0,1]
    v_pk_mul_f32 v[152:153], v[176:177], v[184:185] op_sel_hi:[1,0]
    v_pk_mul_f32 v[174:175], v[174:175], v[184:185] op_sel:[0,1] op_sel_hi:[1,1]
    v_pk_add_f32 v[190:191], v[190:191], v[144:145]
    v_pk_add_f32 v[188:189], v[188:189], v[136:137]
    v_pk_fma_f32 v[132:133], v[132:133], v[184:185], v[172:173] op_sel_hi:[1,0,1]
    v_pk_add_f32 v[186:187], v[186:187], v[130:131]
    v_pk_fma_f32 v[122:123], v[122:123], v[184:185], v[170:171] op_sel_hi:[1,0,1]
    v_pk_mul_f32 v[176:177], v[176:177], v[184:185] op_sel:[0,1] op_sel_hi:[1,1]
    v_pk_fma_f32 v[166:167], v[166:167], v[184:185], v[174:175] op_sel_hi:[1,0,1]
    v_pk_fma_f32 v[162:163], v[162:163], v[184:185], v[174:175] op_sel_hi:[1,0,1]
    v_pk_add_f32 v[186:187], v[186:187], v[132:133]
    v_pk_fma_f32 v[124:125], v[124:125], v[184:185], v[172:173] op_sel_hi:[1,0,1]
    v_pk_add_f32 v[182:183], v[182:183], v[122:123]
    v_pk_fma_f32 v[118:119], v[118:119], v[184:185], v[170:171] op_sel_hi:[1,0,1]
    v_pk_fma_f32 v[168:169], v[168:169], v[184:185], v[176:177] op_sel_hi:[1,0,1]
    v_pk_add_f32 v[190:191], v[190:191], v[166:167]
    v_pk_fma_f32 v[164:165], v[164:165], v[184:185], v[176:177] op_sel_hi:[1,0,1]
    v_pk_add_f32 v[188:189], v[188:189], v[162:163]
    v_pk_fma_f32 v[158:159], v[158:159], v[184:185], v[174:175] op_sel_hi:[1,0,1]
    v_pk_add_f32 v[182:183], v[182:183], v[124:125]
    v_pk_fma_f32 v[120:121], v[120:121], v[184:185], v[172:173] op_sel_hi:[1,0,1]
    v_pk_add_f32 v[180:181], v[180:181], v[118:119]
    v_pk_fma_f32 v[98:99], v[98:99], v[184:185], v[170:171] op_sel_hi:[1,0,1]
    v_pk_add_f32 v[190:191], v[190:191], v[168:169]
    v_pk_add_f32 v[188:189], v[188:189], v[164:165]
    v_pk_fma_f32 v[160:161], v[160:161], v[184:185], v[176:177] op_sel_hi:[1,0,1]
    v_pk_add_f32 v[186:187], v[186:187], v[158:159]
    v_pk_fma_f32 v[154:155], v[154:155], v[184:185], v[174:175] op_sel_hi:[1,0,1]
    v_pk_add_f32 v[180:181], v[180:181], v[120:121]
    v_pk_fma_f32 v[100:101], v[100:101], v[184:185], v[172:173] op_sel_hi:[1,0,1]
    v_pk_add_f32 v[178:179], v[178:179], v[98:99]
    v_pk_add_f32 v[186:187], v[186:187], v[160:161]
    v_pk_fma_f32 v[156:157], v[156:157], v[184:185], v[176:177] op_sel_hi:[1,0,1]
    v_pk_add_f32 v[182:183], v[182:183], v[154:155]
    v_pk_fma_f32 v[146:147], v[146:147], v[184:185], v[174:175] op_sel_hi:[1,0,1]
    v_add_f32 v190, v190, v191
    v_add_f32 v188, v188, v189
    v_pk_add_f32 v[178:179], v[178:179], v[100:101]
    v_pk_add_f32 v[182:183], v[182:183], v[156:157]
    v_pk_fma_f32 v[148:149], v[148:149], v[184:185], v[176:177] op_sel_hi:[1,0,1]
    v_pk_add_f32 v[180:181], v[180:181], v[146:147]
    v_pk_fma_f32 v[126:127], v[126:127], v[184:185], v[174:175] op_sel_hi:[1,0,1]
    v_mov_b32 v191, v190
    v_mov_b32 v189, v188
    v_add_f32_e64 v186, v186, v187
    v_pk_add_f32 v[180:181], v[180:181], v[148:149]
    v_pk_fma_f32 v[128:129], v[128:129], v[184:185], v[176:177] op_sel_hi:[1,0,1]
    v_pk_add_f32 v[178:179], v[178:179], v[126:127]
    v_mov_b32 v187, v186
    v_add_f32 v182, v182, v183
    v_pk_add_f32 v[178:179], v[178:179], v[128:129]
    v_mov_b32 v183, v182
    v_add_f32 v180, v180, v181
    v_permlane32_swap_b32 v190, v191
    v_permlane32_swap_b32 v188, v189
    v_mov_b32 v181, v180
    v_add_f32 v178, v178, v179
    v_permlane32_swap_b32 v186, v187
    v_mov_b32 v179, v178
    v_add_f32 v190, v190, v191
    v_add_f32 v188, v188, v189
    v_permlane32_swap_b32 v182, v183
    v_mov_b32 v191, v190
    v_mov_b32 v189, v188
    v_add_f32 v186, v186, v187
    v_permlane32_swap_b32 v180, v181
    v_mov_b32 v187, v186
    v_add_f32 v182, v182, v183
    v_permlane32_swap_b32 v178, v179
    v_mov_b32 v183, v182
    v_add_f32 v180, v180, v181
    v_permlane16_swap_b32 v190, v191
    v_permlane16_swap_b32 v188, v189
    v_mov_b32 v181, v180
    v_add_f32 v178, v178, v179
    v_permlane16_swap_b32 v186, v187
    v_mov_b32 v179, v178
    v_add_f32 v190, v190, v191
    v_add_f32 v188, v188, v189
    v_permlane16_swap_b32 v182, v183
    v_mul_f32 v190, 0xbc2aaaab, v190
    v_mul_f32 v188, 0xbc2aaaab, v188
    v_add_f32 v186, v186, v187
    v_permlane16_swap_b32 v180, v181
    v_mul_f32 v186, 0xbc2aaaab, v186
    v_add_f32 v182, v182, v183
    v_permlane16_swap_b32 v178, v179
    v_add_f32 v174, v190, v188
    v_mul_f32 v182, 0xbc2aaaab, v182
    v_add_f32 v180, v180, v181
    v_add_f32 v174, v174, v186
    v_mul_f32 v180, 0xbc2aaaab, v180
    v_add_f32 v178, v178, v179
    v_add_f32 v174, v174, v182
    v_mul_f32 v178, 0xbc2aaaab, v178
    v_add_f32 v174, v174, v180
    v_add_f32 v174, v174, v178
    v_pk_add_f32 v[38:39], v[38:39], v[190:191] op_sel_hi:[1,0]
    v_pk_add_f32 v[40:41], v[40:41], v[190:191] op_sel_hi:[1,0]
    v_add_f32_dpp v174, v174, v174 row_ror:8 row_mask:0xf bank_mask:0xf
    v_pk_add_f32 v[58:59], v[58:59], v[190:191] op_sel_hi:[1,0]
    v_pk_add_f32 v[60:61], v[60:61], v[190:191] op_sel_hi:[1,0]
    v_add_f32_dpp v174, v174, v174 row_ror:4 row_mask:0xf bank_mask:0xf
    v_pk_add_f32 v[86:87], v[86:87], v[190:191] op_sel_hi:[1,0]
    v_pk_add_f32 v[88:89], v[88:89], v[190:191] op_sel_hi:[1,0]
    v_add_f32_dpp v174, v174, v174 row_ror:2 row_mask:0xf bank_mask:0xf
    v_pk_add_f32 v[114:115], v[114:115], v[190:191] op_sel_hi:[1,0]
    v_pk_add_f32 v[116:117], v[116:117], v[190:191] op_sel_hi:[1,0]
    v_add_f32_dpp v174, v174, v174 row_ror:1 row_mask:0xf bank_mask:0xf
    v_mov_b32_e64 v175, v174
    v_cvt_pk_bf16_f32 v170, v38, v39
    v_cvt_pk_bf16_f32 v171, v40, v41
    v_cvt_pk_bf16_f32 v172, v58, v59
    v_cvt_pk_bf16_f32 v173, v60, v61
    v_cvt_pk_bf16_f32 v38, v86, v87
    v_cvt_pk_bf16_f32 v39, v88, v89
    v_cvt_pk_bf16_f32 v40, v114, v115
    v_cvt_pk_bf16_f32 v41, v116, v117
    ds_write_b128 v193, v[170:173]
    v_pk_add_f32 v[142:143], v[142:143], v[190:191] op_sel_hi:[1,0]
    v_pk_add_f32 v[144:145], v[144:145], v[190:191] op_sel_hi:[1,0]
    v_pk_add_f32 v[166:167], v[166:167], v[190:191] op_sel_hi:[1,0]
    v_pk_add_f32 v[168:169], v[168:169], v[190:191] op_sel_hi:[1,0]
    v_cvt_pk_bf16_f32 v58, v142, v143
    v_cvt_pk_bf16_f32 v59, v144, v145
    v_cvt_pk_bf16_f32 v60, v166, v167
    v_cvt_pk_bf16_f32 v61, v168, v169
    ds_write_b128 v193, v[38:41] offset:2048
    v_pk_add_f32 v[30:31], v[30:31], v[188:189] op_sel_hi:[1,0]
    v_pk_add_f32 v[32:33], v[32:33], v[188:189] op_sel_hi:[1,0]
    v_pk_add_f32 v[54:55], v[54:55], v[188:189] op_sel_hi:[1,0]
    v_pk_add_f32 v[56:57], v[56:57], v[188:189] op_sel_hi:[1,0]
    v_cvt_pk_bf16_f32 v30, v30, v31
    v_cvt_pk_bf16_f32 v31, v32, v33
    v_cvt_pk_bf16_f32 v32, v54, v55
    v_cvt_pk_bf16_f32 v33, v56, v57
    ds_write_b128 v193, v[58:61] offset:4096
    v_pk_add_f32 v[78:79], v[78:79], v[188:189] op_sel_hi:[1,0]
    v_pk_add_f32 v[80:81], v[80:81], v[188:189] op_sel_hi:[1,0]
    v_pk_add_f32 v[106:107], v[106:107], v[188:189] op_sel_hi:[1,0]
    v_pk_add_f32 v[108:109], v[108:109], v[188:189] op_sel_hi:[1,0]
    v_cvt_pk_bf16_f32 v38, v78, v79
    v_cvt_pk_bf16_f32 v39, v80, v81
    v_cvt_pk_bf16_f32 v40, v106, v107
    v_cvt_pk_bf16_f32 v41, v108, v109
    ds_write_b128 v193, v[30:33] offset:256
    v_pk_add_f32 v[134:135], v[134:135], v[188:189] op_sel_hi:[1,0]
    v_pk_add_f32 v[136:137], v[136:137], v[188:189] op_sel_hi:[1,0]
    v_pk_add_f32 v[162:163], v[162:163], v[188:189] op_sel_hi:[1,0]
    v_pk_add_f32 v[164:165], v[164:165], v[188:189] op_sel_hi:[1,0]
    v_cvt_pk_bf16_f32 v30, v134, v135
    v_cvt_pk_bf16_f32 v31, v136, v137
    v_cvt_pk_bf16_f32 v32, v162, v163
    v_cvt_pk_bf16_f32 v33, v164, v165
    ds_write_b128 v193, v[38:41] offset:2304
    v_pk_add_f32 v[22:23], v[22:23], v[186:187] op_sel_hi:[1,0]
    v_pk_add_f32 v[24:25], v[24:25], v[186:187] op_sel_hi:[1,0]
    v_pk_add_f32 v[46:47], v[46:47], v[186:187] op_sel_hi:[1,0]
    v_pk_add_f32 v[48:49], v[48:49], v[186:187] op_sel_hi:[1,0]
    v_cvt_pk_bf16_f32 v22, v22, v23
    v_cvt_pk_bf16_f32 v23, v24, v25
    v_cvt_pk_bf16_f32 v24, v46, v47
    v_cvt_pk_bf16_f32 v25, v48, v49
    ds_write_b128 v193, v[30:33] offset:4352
    v_pk_add_f32 v[70:71], v[70:71], v[186:187] op_sel_hi:[1,0]
    v_pk_add_f32 v[72:73], v[72:73], v[186:187] op_sel_hi:[1,0]
    v_pk_add_f32 v[102:103], v[102:103], v[186:187] op_sel_hi:[1,0]
    v_pk_add_f32 v[104:105], v[104:105], v[186:187] op_sel_hi:[1,0]
    v_cvt_pk_bf16_f32 v30, v70, v71
    v_cvt_pk_bf16_f32 v31, v72, v73
    v_cvt_pk_bf16_f32 v32, v102, v103
    v_cvt_pk_bf16_f32 v33, v104, v105
    ds_write_b128 v193, v[22:25] offset:6144
    v_pk_add_f32 v[130:131], v[130:131], v[186:187] op_sel_hi:[1,0]
    v_pk_add_f32 v[132:133], v[132:133], v[186:187] op_sel_hi:[1,0]
    v_pk_add_f32 v[158:159], v[158:159], v[186:187] op_sel_hi:[1,0]
    v_pk_add_f32 v[160:161], v[160:161], v[186:187] op_sel_hi:[1,0]
    v_cvt_pk_bf16_f32 v22, v130, v131
    v_cvt_pk_bf16_f32 v23, v132, v133
    v_cvt_pk_bf16_f32 v24, v158, v159
    v_cvt_pk_bf16_f32 v25, v160, v161
    ds_write_b128 v193, v[30:33] offset:8192
    v_pk_add_f32 v[10:11], v[10:11], v[182:183] op_sel_hi:[1,0]
    v_pk_add_f32 v[12:13], v[12:13], v[182:183] op_sel_hi:[1,0]
    v_pk_add_f32 v[34:35], v[34:35], v[182:183] op_sel_hi:[1,0]
    v_pk_add_f32 v[36:37], v[36:37], v[182:183] op_sel_hi:[1,0]
    v_cvt_pk_bf16_f32 v10, v10, v11
    v_cvt_pk_bf16_f32 v11, v12, v13
    v_cvt_pk_bf16_f32 v12, v34, v35
    v_cvt_pk_bf16_f32 v13, v36, v37
    ds_write_b128 v193, v[22:25] offset:10240
    v_pk_add_f32 v[66:67], v[66:67], v[182:183] op_sel_hi:[1,0]
    v_pk_add_f32 v[68:69], v[68:69], v[182:183] op_sel_hi:[1,0]
    v_pk_add_f32 v[94:95], v[94:95], v[182:183] op_sel_hi:[1,0]
    v_pk_add_f32 v[96:97], v[96:97], v[182:183] op_sel_hi:[1,0]
    v_cvt_pk_bf16_f32 v22, v66, v67
    v_cvt_pk_bf16_f32 v23, v68, v69
    v_cvt_pk_bf16_f32 v24, v94, v95
    v_cvt_pk_bf16_f32 v25, v96, v97
    ds_write_b128 v193, v[10:13] offset:6400
    v_pk_add_f32 v[122:123], v[122:123], v[182:183] op_sel_hi:[1,0]
    v_pk_add_f32 v[124:125], v[124:125], v[182:183] op_sel_hi:[1,0]
    v_pk_add_f32 v[154:155], v[154:155], v[182:183] op_sel_hi:[1,0]
    v_pk_add_f32 v[156:157], v[156:157], v[182:183] op_sel_hi:[1,0]
    v_cvt_pk_bf16_f32 v10, v122, v123
    v_cvt_pk_bf16_f32 v11, v124, v125
    v_cvt_pk_bf16_f32 v12, v154, v155
    v_cvt_pk_bf16_f32 v13, v156, v157
    ds_write_b128 v193, v[22:25] offset:8448
    v_pk_add_f32 v[6:7], v[6:7], v[180:181] op_sel_hi:[1,0]
    v_pk_add_f32 v[8:9], v[8:9], v[180:181] op_sel_hi:[1,0]
    v_pk_add_f32 v[26:27], v[26:27], v[180:181] op_sel_hi:[1,0]
    v_pk_add_f32 v[28:29], v[28:29], v[180:181] op_sel_hi:[1,0]
    v_cvt_pk_bf16_f32 v6, v6, v7
    v_cvt_pk_bf16_f32 v7, v8, v9
    v_cvt_pk_bf16_f32 v8, v26, v27
    v_cvt_pk_bf16_f32 v9, v28, v29
    ds_write_b128 v193, v[10:13] offset:10496
    v_pk_add_f32 v[62:63], v[62:63], v[180:181] op_sel_hi:[1,0]
    v_pk_add_f32 v[64:65], v[64:65], v[180:181] op_sel_hi:[1,0]
    v_pk_add_f32 v[90:91], v[90:91], v[180:181] op_sel_hi:[1,0]
    v_pk_add_f32 v[92:93], v[92:93], v[180:181] op_sel_hi:[1,0]
    v_cvt_pk_bf16_f32 v10, v62, v63
    v_cvt_pk_bf16_f32 v11, v64, v65
    v_cvt_pk_bf16_f32 v12, v90, v91
    v_cvt_pk_bf16_f32 v13, v92, v93
    ds_write_b128 v193, v[6:9] offset:12288
    v_pk_add_f32 v[118:119], v[118:119], v[180:181] op_sel_hi:[1,0]
    v_pk_add_f32 v[120:121], v[120:121], v[180:181] op_sel_hi:[1,0]
    v_pk_add_f32 v[146:147], v[146:147], v[180:181] op_sel_hi:[1,0]
    v_pk_add_f32 v[148:149], v[148:149], v[180:181] op_sel_hi:[1,0]
    v_cvt_pk_bf16_f32 v6, v118, v119
    v_cvt_pk_bf16_f32 v7, v120, v121
    v_cvt_pk_bf16_f32 v8, v146, v147
    v_cvt_pk_bf16_f32 v9, v148, v149
    ds_write_b128 v193, v[10:13] offset:14336
    v_pk_add_f32 v[2:3], v[2:3], v[178:179] op_sel_hi:[1,0]
    v_pk_add_f32 v[4:5], v[4:5], v[178:179] op_sel_hi:[1,0]
    v_pk_add_f32 v[14:15], v[14:15], v[178:179] op_sel_hi:[1,0]
    v_pk_add_f32 v[16:17], v[16:17], v[178:179] op_sel_hi:[1,0]
    v_cvt_pk_bf16_f32 v2, v2, v3
    v_cvt_pk_bf16_f32 v3, v4, v5
    v_cvt_pk_bf16_f32 v4, v14, v15
    v_cvt_pk_bf16_f32 v5, v16, v17
    ds_write_b128 v193, v[6:9] offset:16384
    v_pk_add_f32 v[18:19], v[18:19], v[174:175] op_sel_hi:[1,0]
    v_pk_add_f32 v[20:21], v[20:21], v[174:175] op_sel_hi:[1,0]
    v_pk_add_f32 v[50:51], v[50:51], v[174:175] op_sel_hi:[1,0]
    v_pk_add_f32 v[52:53], v[52:53], v[174:175] op_sel_hi:[1,0]
    v_pk_add_f32 v[82:83], v[82:83], v[174:175] op_sel_hi:[1,0]
    v_pk_add_f32 v[84:85], v[84:85], v[174:175] op_sel_hi:[1,0]
    v_pk_add_f32 v[110:111], v[110:111], v[174:175] op_sel_hi:[1,0]
    v_pk_add_f32 v[112:113], v[112:113], v[174:175] op_sel_hi:[1,0]
    v_pk_add_f32 v[138:139], v[138:139], v[174:175] op_sel_hi:[1,0]
    v_pk_add_f32 v[140:141], v[140:141], v[174:175] op_sel_hi:[1,0]
    v_pk_add_f32 v[150:151], v[150:151], v[174:175] op_sel_hi:[1,0]
    v_pk_add_f32 v[152:153], v[152:153], v[174:175] op_sel_hi:[1,0]
    v_pk_add_f32 v[42:43], v[42:43], v[178:179] op_sel_hi:[1,0]
    v_pk_add_f32 v[44:45], v[44:45], v[178:179] op_sel_hi:[1,0]
    v_pk_add_f32 v[74:75], v[74:75], v[178:179] op_sel_hi:[1,0]
    v_pk_add_f32 v[76:77], v[76:77], v[178:179] op_sel_hi:[1,0]
    v_cvt_pk_bf16_f32 v6, v18, v19
    v_cvt_pk_bf16_f32 v7, v20, v21
    v_cvt_pk_bf16_f32 v8, v50, v51
    v_cvt_pk_bf16_f32 v9, v52, v53
    v_cvt_pk_bf16_f32 v10, v82, v83
    v_cvt_pk_bf16_f32 v11, v84, v85
    v_cvt_pk_bf16_f32 v12, v110, v111
    v_cvt_pk_bf16_f32 v13, v112, v113
    v_cvt_pk_bf16_f32 v14, v138, v139
    v_cvt_pk_bf16_f32 v15, v140, v141
    v_cvt_pk_bf16_f32 v16, v150, v151
    v_cvt_pk_bf16_f32 v17, v152, v153
    v_cvt_pk_bf16_f32 v18, v42, v43
    v_cvt_pk_bf16_f32 v19, v44, v45
    v_cvt_pk_bf16_f32 v20, v74, v75
    v_cvt_pk_bf16_f32 v21, v76, v77
    v_cndmask_b32_e64 v6, v192, v6, s[32:33]
    v_cndmask_b32_e64 v7, v192, v7, s[32:33]
    v_cndmask_b32_e64 v8, v192, v8, s[32:33]
    v_cndmask_b32_e64 v9, v192, v9, s[32:33]
    v_cndmask_b32_e64 v10, v192, v10, s[32:33]
    v_cndmask_b32_e64 v11, v192, v11, s[32:33]
    v_cndmask_b32_e64 v12, v192, v12, s[32:33]
    v_cndmask_b32_e64 v13, v192, v13, s[32:33]
    v_cndmask_b32_e64 v14, v192, v14, s[32:33]
    v_cndmask_b32_e64 v15, v192, v15, s[32:33]
    v_cndmask_b32_e64 v16, v192, v16, s[32:33]
    v_cndmask_b32_e64 v17, v192, v17, s[32:33]
    s_waitcnt lgkmcnt(14)
    ds_write_b128 v193, v[2:5] offset:12544
    v_pk_add_f32 v[98:99], v[98:99], v[178:179] op_sel_hi:[1,0]
    v_pk_add_f32 v[100:101], v[100:101], v[178:179] op_sel_hi:[1,0]
    v_pk_add_f32 v[126:127], v[126:127], v[178:179] op_sel_hi:[1,0]
    v_pk_add_f32 v[128:129], v[128:129], v[178:179] op_sel_hi:[1,0]
    v_cvt_pk_bf16_f32 v2, v98, v99
    v_cvt_pk_bf16_f32 v3, v100, v101
    v_cvt_pk_bf16_f32 v4, v126, v127
    v_cvt_pk_bf16_f32 v5, v128, v129
    s_waitcnt lgkmcnt(14)
    ds_write_b128 v193, v[18:21] offset:14592
    s_waitcnt lgkmcnt(14)
    ds_write_b128 v193, v[2:5] offset:16640
    s_waitcnt lgkmcnt(14)
    ds_write_b128 v1, v[6:9]
    s_waitcnt lgkmcnt(14)
    ds_write_b128 v1, v[10:13] offset:1024
    s_waitcnt lgkmcnt(14)
    ds_write_b128 v1, v[14:17] offset:2048
    s_waitcnt lgkmcnt(0) vmcnt(0)
    s_nop 0
    v_accvgpr_read_b32 v4, a144
    v_accvgpr_read_b32 v5, a145
    v_accvgpr_read_b32 v6, a146
    v_accvgpr_read_b32 v7, a147
    v_accvgpr_read_b32 v10, a148
    v_accvgpr_read_b32 v11, a149
    v_accvgpr_read_b32 v12, a150
    v_accvgpr_read_b32 v13, a151
    v_accvgpr_read_b32 v16, a152
    v_accvgpr_read_b32 v17, a153
    v_accvgpr_read_b32 v18, a154
    v_accvgpr_read_b32 v19, a155
    s_barrier
    v_mfma_f32_16x16x32_bf16 v[0:3], v[4:7], v[4:7], 0
    s_add_u32 m0, s43, 37632
    ds_read_b128 v[58:61], v232
    ds_read_b128 v[64:67], v232 offset:64
    v_mfma_f32_16x16x32_bf16 v[0:3], v[10:13], v[10:13], v[0:3]
    s_mov_b64 vcc, s[38:39]
    ds_read_b128 v[70:73], v232 offset:128
    buffer_load_dwordx4 v212, s[4:7], s25 offen nt lds
    v_mfma_f32_16x16x32_bf16 v[0:3], v[16:19], v[16:19], v[0:3]
    s_add_u32 m0, s43, 38656
    ds_read_b128 v[40:43], v233
    v_subrev_u32 v9, s43, v230
    v_add_u32 v9, 159168, v9
    ds_read_b128 v[238:241], v9
    v_mov_b32 v128, 1073741824
    ds_read_b128 v[242:245], v9 offset:1024
    s_nop 0
    s_nop 0
    v_cndmask_b32_e64 v8, v0, v1, s[32:33]
    ds_read_b128 v[246:249], v9 offset:2048
    buffer_load_dwordx4 v213, s[4:7], s25 offen nt lds
    s_add_u32 m0, s43, 39680
    ds_read_b128 v[46:49], v233 offset:64
    v_cndmask_b32_e64 v8, v8, v2, s[34:35]
    ds_read_b128 v[52:55], v233 offset:128
    v_cndmask_b32_e64 v8, v8, v3, s[36:37]
    ds_read_b128 v[22:25], v234
    ds_read_b128 v[28:31], v234 offset:64
    buffer_load_dwordx4 v214, s[4:7], s25 offen nt lds
    s_add_u32 m0, s43, 40704
    ds_read_b128 v[34:37], v234 offset:128
    ds_read_b128 a[72:75], v207 offset:18432
    s_waitcnt lgkmcnt(8)
    v_mfma_f32_16x16x32_bf16 v[76:79], v[238:241], v[4:7], 0
    ds_read_b128 a[76:79], v207 offset:20480
    s_waitcnt lgkmcnt(8)
    v_mfma_f32_16x16x32_bf16 v[76:79], v[242:245], v[10:13], v[76:79]
    ds_read_b128 a[80:83], v207 offset:22528
    buffer_load_dwordx4 v215, s[4:7], s25 offen nt lds
    s_waitcnt lgkmcnt(8)
    v_mfma_f32_16x16x32_bf16 v[76:79], v[246:249], v[16:19], v[76:79]
    s_add_u32 m0, s43, 41728
    ds_read_b128 a[84:87], v207 offset:19456
    v_mfma_f32_16x16x32_bf16 v[84:87], v[58:61], v[58:61], 0
    ds_read_b128 a[88:91], v207 offset:21504
    v_mfma_f32_16x16x32_bf16 v[84:87], v[64:67], v[64:67], v[84:87]
    ds_read_b128 a[92:95], v207 offset:23552
    v_mfma_f32_16x16x32_bf16 v[84:87], v[70:73], v[70:73], v[84:87]
    ds_read_b128 a[96:99], v207 offset:24576
    buffer_load_dwordx4 v216, s[4:7], s25 offen nt lds
    v_mfma_f32_16x16x32_bf16 v[0:3], v[238:241], v[58:61], 0
    s_add_u32 m0, s43, 42752
    ds_read_b128 a[100:103], v207 offset:26624
    v_mfma_f32_16x16x32_bf16 v[0:3], v[242:245], v[64:67], v[0:3]
    ds_read_b128 a[104:107], v207 offset:28672
    v_cndmask_b32_e64 v9, v84, v85, s[32:33]
    v_mfma_f32_16x16x32_bf16 v[0:3], v[246:249], v[70:73], v[0:3]
    ds_read_b128 a[108:111], v207 offset:25600
    v_cndmask_b32_e64 v9, v9, v86, s[34:35]
    v_mfma_f32_16x16x32_bf16 v[82:85], v[40:43], v[40:43], 0
    s_waitcnt lgkmcnt(14)
    ds_read_b128 a[112:115], v207 offset:27648
    buffer_load_dwordx4 v217, s[4:7], s25 offen nt lds
    v_mfma_f32_16x16x32_bf16 v[82:85], v[46:49], v[46:49], v[82:85]
    s_add_u32 m0, s43, 43776
    s_waitcnt lgkmcnt(14)
    ds_read_b128 a[116:119], v207 offset:29696
    v_cndmask_b32_e64 v9, v9, v87, s[36:37]
    v_mfma_f32_16x16x32_bf16 v[82:85], v[52:55], v[52:55], v[82:85]
    s_waitcnt lgkmcnt(14)
    ds_read_b128 a[0:3], v207 offset:37632
    v_mfma_f32_16x16x32_bf16 v[78:81], v[238:241], v[40:43], 0
    s_waitcnt lgkmcnt(14)
    ds_read_b128 a[4:7], v207 offset:39680
    v_mfma_f32_16x16x32_bf16 v[78:81], v[242:245], v[46:49], v[78:81]
    s_waitcnt lgkmcnt(14)
    ds_read_b128 a[120:123], v207 offset:30720
    buffer_load_dwordx4 v218, s[4:7], s25 offen nt lds
    v_mfma_f32_16x16x32_bf16 v[78:81], v[246:249], v[52:55], v[78:81]
    s_add_u32 m0, s43, 44800
    s_waitcnt lgkmcnt(14)
    ds_read_b128 a[8:11], v207 offset:41728
    v_cndmask_b32_e64 v2, v82, v83, s[32:33]
    v_mfma_f32_16x16x32_bf16 v[86:89], v[22:25], v[22:25], 0
    s_waitcnt lgkmcnt(14)
    ds_read_b128 a[12:15], v207 offset:38656
    v_cndmask_b32_e64 v2, v2, v84, s[34:35]
    v_mfma_f32_16x16x32_bf16 v[86:89], v[28:31], v[28:31], v[86:89]
    s_waitcnt lgkmcnt(14)
    ds_read_b128 a[124:127], v207 offset:32768
    v_cndmask_b32_e64 v2, v2, v85, s[36:37]
    v_mfma_f32_16x16x32_bf16 v[86:89], v[34:37], v[34:37], v[86:89]
    s_waitcnt lgkmcnt(14)
    ds_read_b128 a[16:19], v207 offset:40704
    buffer_load_dwordx4 v219, s[4:7], s25 offen nt lds
    v_mfma_f32_16x16x32_bf16 v[80:83], v[238:241], v[22:25], 0
    s_add_u32 m0, s43, 45824
    s_waitcnt lgkmcnt(14)
    ds_read_b128 a[20:23], v207 offset:42752
    v_cndmask_b32_dpp v9, v2, v9, vcc row_ror:4 row_mask:0xf bank_mask:0xf
    v_mfma_f32_16x16x32_bf16 v[80:83], v[242:245], v[28:31], v[80:83]
    s_waitcnt lgkmcnt(14)
    ds_read_b128 a[128:131], v207 offset:34816
    v_cndmask_b32_e64 v2, v86, v87, s[32:33]
    v_mfma_f32_16x16x32_bf16 v[80:83], v[246:249], v[34:37], v[80:83]
    s_waitcnt lgkmcnt(14)
    ds_read_b128 a[24:27], v207 offset:43776
    v_cndmask_b32_e64 v2, v2, v88, s[34:35]
    v_mfma_f32_16x16x32_bf16 v[84:87], a[72:75], v[58:61], 0
    s_waitcnt lgkmcnt(14)
    ds_read_b128 a[28:31], v207 offset:45824
    buffer_load_dwordx4 v220, s[4:7], s25 offen nt lds
    v_mfma_f32_16x16x32_bf16 v[84:87], a[76:79], v[64:67], v[84:87]
    s_waitcnt lgkmcnt(14)
    ds_read_b128 a[132:135], v207 offset:31744
    v_cndmask_b32_e64 v2, v2, v89, s[36:37]
    v_mfma_f32_16x16x32_bf16 v[84:87], a[80:83], v[70:73], v[84:87]
    s_waitcnt lgkmcnt(14)
    ds_read_b128 a[32:35], v207 offset:47872
    v_cndmask_b32_dpp v26, v78, v0, vcc row_ror:4 row_mask:0xf bank_mask:0xf
    v_mfma_f32_16x16x32_bf16 v[88:91], a[72:75], v[40:43], 0
    s_waitcnt lgkmcnt(14)
    ds_read_b128 a[36:39], v207 offset:44800
    v_cndmask_b32_dpp v27, v79, v1, vcc row_ror:4 row_mask:0xf bank_mask:0xf
    v_mfma_f32_16x16x32_bf16 v[88:91], a[76:79], v[46:49], v[88:91]
    s_mov_b64 vcc, s[40:41]
    s_waitcnt lgkmcnt(14)
    ds_read_b128 a[136:139], v207 offset:33792
    v_cvt_pk_bf16_f32 v0, v84, v85
    v_mfma_f32_16x16x32_bf16 v[88:91], a[80:83], v[52:55], v[88:91]
    s_waitcnt lgkmcnt(14)
    ds_read_b128 a[40:43], v207 offset:46848
    v_cvt_pk_bf16_f32 v1, v86, v87
    v_mfma_f32_16x16x32_bf16 v[82:85], a[72:75], v[22:25], 0
    s_waitcnt lgkmcnt(14)
    ds_read_b128 a[44:47], v207 offset:48896
    v_cndmask_b32_dpp v9, v2, v9, vcc row_ror:8 row_mask:0xf bank_mask:0xf
    v_mfma_f32_16x16x32_bf16 v[82:85], a[76:79], v[28:31], v[82:85]
    s_waitcnt lgkmcnt(14)
    ds_read_b128 a[140:143], v207 offset:35840
    v_cvt_pk_bf16_f32 v74, v88, v89
    v_mfma_f32_16x16x32_bf16 v[82:85], a[80:83], v[34:37], v[82:85]
    s_waitcnt lgkmcnt(14)
    ds_read_b128 a[48:51], v207 offset:49920
    v_cvt_pk_bf16_f32 v75, v90, v91
    v_mfma_f32_16x16x32_bf16 v[88:91], a[72:75], v[4:7], 0
    s_waitcnt lgkmcnt(14)
    ds_read_b128 a[52:55], v207 offset:51968
    v_cndmask_b32_dpp v26, v80, v26, vcc row_ror:8 row_mask:0xf bank_mask:0xf
    v_mfma_f32_16x16x32_bf16 v[88:91], a[76:79], v[10:13], v[88:91]
    v_cvt_pk_bf16_f32 v78, v82, v83
    v_cvt_pk_bf16_f32 v79, v84, v85
    v_mfma_f32_16x16x32_bf16 v[88:91], a[80:83], v[16:19], v[88:91]
    s_waitcnt lgkmcnt(14)
    ds_read_b128 a[56:59], v207 offset:54016
    v_cndmask_b32_dpp v27, v81, v27, vcc row_ror:8 row_mask:0xf bank_mask:0xf
    v_mfma_f32_16x16x32_bf16 v[84:87], a[84:87], v[58:61], 0
    s_mov_b64 vcc, s[44:45]
    s_waitcnt lgkmcnt(14)
    ds_read_b128 a[60:63], v207 offset:50944
    v_cndmask_b32_dpp v26, v76, v26, vcc row_ror:12 row_mask:0xf bank_mask:0xf
    v_mfma_f32_16x16x32_bf16 v[84:87], a[88:91], v[64:67], v[84:87]
    v_cvt_pk_bf16_f32 v82, v88, v89
    v_cvt_pk_bf16_f32 v83, v90, v91
    v_mfma_f32_16x16x32_bf16 v[84:87], a[92:95], v[70:73], v[84:87]
    s_waitcnt lgkmcnt(14)
    ds_read_b128 a[64:67], v207 offset:52992
    v_cndmask_b32_dpp v9, v8, v9, vcc row_ror:12 row_mask:0xf bank_mask:0xf
    v_mfma_f32_16x16x32_bf16 v[88:91], a[84:87], v[40:43], 0
    s_waitcnt lgkmcnt(14)
    ds_read_b128 a[68:71], v207 offset:55040
    v_cndmask_b32_dpp v27, v77, v27, vcc row_ror:12 row_mask:0xf bank_mask:0xf
    v_mfma_f32_16x16x32_bf16 v[88:91], a[88:91], v[46:49], v[88:91]
    s_mov_b64 vcc, s[38:39]
    v_cvt_pk_bf16_f32 v2, v84, v85
    v_cvt_pk_bf16_f32 v3, v86, v87
    v_mfma_f32_16x16x32_bf16 v[88:91], a[92:95], v[52:55], v[88:91]
    s_waitcnt lgkmcnt(14)
    ds_read_b128 a[144:147], v207 offset:0
    v_mul_f32 v8, v26, v26
    v_mfma_f32_16x16x32_bf16 v[84:87], a[84:87], v[22:25], 0
    s_waitcnt lgkmcnt(14)
    ds_read_b128 a[148:151], v207 offset:2048
    v_fmamk_f32 v8, v8, 0xbc2aaaab, v9
    v_mfma_f32_16x16x32_bf16 v[84:87], a[88:91], v[28:31], v[84:87]
    v_cvt_pk_bf16_f32 v76, v88, v89
    v_cvt_pk_bf16_f32 v77, v90, v91
    v_mfma_f32_16x16x32_bf16 v[84:87], a[92:95], v[34:37], v[84:87]
    s_waitcnt lgkmcnt(14)
    ds_read_b128 a[152:155], v207 offset:4096
    v_add_f32_e64 v8, |v8|, s51
    v_mfma_f32_16x16x32_bf16 v[88:91], a[84:87], v[4:7], 0
    s_waitcnt lgkmcnt(14)
    ds_read_b128 a[156:159], v207 offset:1024
    v_mfma_f32_16x16x32_bf16 v[88:91], a[88:91], v[10:13], v[88:91]
    v_cvt_pk_bf16_f32 v80, v84, v85
    v_cvt_pk_bf16_f32 v81, v86, v87
    v_mfma_f32_16x16x32_bf16 v[88:91], a[92:95], v[16:19], v[88:91]
    s_waitcnt lgkmcnt(14)
    ds_read_b128 a[160:163], v207 offset:3072
    v_mfma_f32_16x16x32_bf16 v[92:95], a[96:99], v[58:61], 0
    s_waitcnt lgkmcnt(14)
    ds_read_b128 a[164:167], v207 offset:5120
    v_mfma_f32_16x16x32_bf16 v[92:95], a[100:103], v[64:67], v[92:95]
    v_cvt_pk_bf16_f32 v84, v88, v89
    v_cvt_pk_bf16_f32 v85, v90, v91
    v_mfma_f32_16x16x32_bf16 v[92:95], a[104:107], v[70:73], v[92:95]
    s_waitcnt lgkmcnt(14)
    ds_read_b128 a[168:171], v207 offset:6144
    v_mfma_f32_16x16x32_bf16 v[96:99], a[96:99], v[40:43], 0
    s_waitcnt lgkmcnt(14)
    ds_read_b128 a[172:175], v207 offset:8192
    v_mfma_f32_16x16x32_bf16 v[96:99], a[100:103], v[46:49], v[96:99]
    v_cvt_pk_bf16_f32 v86, v92, v93
    v_cvt_pk_bf16_f32 v87, v94, v95
    v_mfma_f32_16x16x32_bf16 v[96:99], a[104:107], v[52:55], v[96:99]
    s_waitcnt lgkmcnt(14)
    ds_read_b128 a[176:179], v207 offset:10240
    v_mfma_f32_16x16x32_bf16 v[92:95], a[96:99], v[22:25], 0
    s_waitcnt lgkmcnt(14)
    ds_read_b128 a[180:183], v207 offset:7168
    v_mfma_f32_16x16x32_bf16 v[92:95], a[100:103], v[28:31], v[92:95]
    v_cvt_pk_bf16_f32 v90, v96, v97
    v_cvt_pk_bf16_f32 v91, v98, v99
    v_mfma_f32_16x16x32_bf16 v[92:95], a[104:107], v[34:37], v[92:95]
    s_waitcnt lgkmcnt(14)
    ds_read_b128 a[184:187], v207 offset:9216
    v_mfma_f32_16x16x32_bf16 v[100:103], a[96:99], v[4:7], 0
    s_waitcnt lgkmcnt(14)
    ds_read_b128 a[188:191], v207 offset:11264
    v_mfma_f32_16x16x32_bf16 v[100:103], a[100:103], v[10:13], v[100:103]
    v_cvt_pk_bf16_f32 v98, v92, v93
    v_cvt_pk_bf16_f32 v99, v94, v95
    v_mfma_f32_16x16x32_bf16 v[100:103], a[104:107], v[16:19], v[100:103]
    s_waitcnt lgkmcnt(14)
    ds_read_b128 a[192:195], v207 offset:12288
    v_mfma_f32_16x16x32_bf16 v[104:107], a[108:111], v[58:61], 0
    s_waitcnt lgkmcnt(14)
    ds_read_b128 a[196:199], v207 offset:14336
    v_mfma_f32_16x16x32_bf16 v[104:107], a[112:115], v[64:67], v[104:107]
    v_cvt_pk_bf16_f32 v94, v100, v101
    v_cvt_pk_bf16_f32 v95, v102, v103
    v_mfma_f32_16x16x32_bf16 v[104:107], a[116:119], v[70:73], v[104:107]
    s_waitcnt lgkmcnt(14)
    ds_read_b128 a[200:203], v207 offset:16384
    v_mfma_f32_16x16x32_bf16 v[100:103], a[108:111], v[40:43], 0
    s_waitcnt lgkmcnt(14)
    ds_read_b128 a[204:207], v207 offset:13312
    v_mfma_f32_16x16x32_bf16 v[100:103], a[112:115], v[46:49], v[100:103]
    v_cvt_pk_bf16_f32 v88, v104, v105
    v_cvt_pk_bf16_f32 v89, v106, v107
    v_mfma_f32_16x16x32_bf16 v[100:103], a[116:119], v[52:55], v[100:103]
    s_waitcnt lgkmcnt(14)
    ds_read_b128 a[208:211], v207 offset:15360
    v_mfma_f32_16x16x32_bf16 v[104:107], a[108:111], v[22:25], 0
    s_waitcnt lgkmcnt(14)
    ds_read_b128 a[212:215], v207 offset:17408
    v_mfma_f32_16x16x32_bf16 v[104:107], a[112:115], v[28:31], v[104:107]
    v_cvt_pk_bf16_f32 v92, v100, v101
    v_cvt_pk_bf16_f32 v93, v102, v103
    v_mfma_f32_16x16x32_bf16 v[104:107], a[116:119], v[34:37], v[104:107]
    s_waitcnt lgkmcnt(14)
    ds_read_b128 a[216:219], v231 offset:0
    v_mfma_f32_16x16x32_bf16 v[108:111], a[108:111], v[4:7], 0
    s_waitcnt lgkmcnt(14)
    ds_read_b128 a[220:223], v231 offset:2048
    v_mfma_f32_16x16x32_bf16 v[108:111], a[112:115], v[10:13], v[108:111]
    v_cvt_pk_bf16_f32 v100, v104, v105
    v_cvt_pk_bf16_f32 v101, v106, v107
    v_mfma_f32_16x16x32_bf16 v[108:111], a[116:119], v[16:19], v[108:111]
    s_waitcnt lgkmcnt(14)
    ds_read_b128 a[224:227], v231 offset:4096
    v_mfma_f32_16x16x32_bf16 v[102:105], a[120:123], v[58:61], 0
    s_waitcnt lgkmcnt(14)
    ds_read_b128 a[228:231], v231 offset:1024
    v_mfma_f32_16x16x32_bf16 v[102:105], a[124:127], v[64:67], v[102:105]
    v_cvt_pk_bf16_f32 v96, v108, v109
    v_cvt_pk_bf16_f32 v97, v110, v111
    v_mfma_f32_16x16x32_bf16 v[102:105], a[128:131], v[70:73], v[102:105]
    s_waitcnt lgkmcnt(14)
    ds_read_b128 a[232:235], v231 offset:3072
    v_mfma_f32_16x16x32_bf16 v[106:109], a[120:123], v[40:43], 0
    s_waitcnt lgkmcnt(14)
    ds_read_b128 a[236:239], v231 offset:5120
    v_mfma_f32_16x16x32_bf16 v[106:109], a[124:127], v[46:49], v[106:109]
    v_cvt_pk_bf16_f32 v102, v102, v103
    v_cvt_pk_bf16_f32 v103, v104, v105
    v_mfma_f32_16x16x32_bf16 v[106:109], a[128:131], v[52:55], v[106:109]
    s_waitcnt lgkmcnt(14)
    ds_read_b128 a[240:243], v231 offset:6144
    v_mfma_f32_16x16x32_bf16 v[114:117], a[120:123], v[22:25], 0
    s_waitcnt lgkmcnt(14)
    ds_read_b128 a[244:247], v231 offset:8192
    v_mfma_f32_16x16x32_bf16 v[114:117], a[124:127], v[28:31], v[114:117]
    v_cvt_pk_bf16_f32 v110, v106, v107
    v_cvt_pk_bf16_f32 v111, v108, v109
    v_mfma_f32_16x16x32_bf16 v[114:117], a[128:131], v[34:37], v[114:117]
    s_waitcnt lgkmcnt(14)
    ds_read_b128 a[248:251], v231 offset:10240
    v_mfma_f32_16x16x32_bf16 v[106:109], a[120:123], v[4:7], 0
    s_waitcnt lgkmcnt(14)
    ds_read_b128 a[252:255], v231 offset:7168
    v_mfma_f32_16x16x32_bf16 v[106:109], a[124:127], v[10:13], v[106:109]
    v_cvt_pk_bf16_f32 v114, v114, v115
    v_cvt_pk_bf16_f32 v115, v116, v117
    v_mfma_f32_16x16x32_bf16 v[106:109], a[128:131], v[16:19], v[106:109]
    v_rsq_f32 v8, v8
    v_mfma_f32_16x16x32_bf16 v[120:123], a[132:135], v[58:61], 0
    v_mfma_f32_16x16x32_bf16 v[120:123], a[136:139], v[64:67], v[120:123]
    v_cvt_pk_bf16_f32 v106, v106, v107
    v_cvt_pk_bf16_f32 v107, v108, v109
    v_mfma_f32_16x16x32_bf16 v[120:123], a[140:143], v[70:73], v[120:123]
    v_mfma_f32_16x16x32_bf16 v[116:119], a[132:135], v[40:43], 0
    v_mfma_f32_16x16x32_bf16 v[116:119], a[136:139], v[46:49], v[116:119]
    v_cvt_pk_bf16_f32 v104, v120, v121
    v_cvt_pk_bf16_f32 v105, v122, v123
    v_mfma_f32_16x16x32_bf16 v[116:119], a[140:143], v[52:55], v[116:119]
    v_mfma_f32_16x16x32_bf16 v[120:123], a[132:135], v[22:25], 0
    s_waitcnt lgkmcnt(0)
    s_barrier
    v_mfma_f32_16x16x32_bf16 v[120:123], a[136:139], v[28:31], v[120:123]
    v_cvt_pk_bf16_f32 v112, v116, v117
    v_cvt_pk_bf16_f32 v113, v118, v119
    v_mfma_f32_16x16x32_bf16 v[120:123], a[140:143], v[34:37], v[120:123]
    v_mfma_f32_16x16x32_bf16 v[124:127], a[132:135], v[4:7], 0
    v_mfma_f32_16x16x32_bf16 v[124:127], a[136:139], v[10:13], v[124:127]
    v_cvt_pk_bf16_f32 v116, v120, v121
    v_cvt_pk_bf16_f32 v117, v122, v123
    v_mfma_f32_16x16x32_bf16 v[124:127], a[140:143], v[16:19], v[124:127]
    v_mfma_f32_16x16x32_bf16 v[118:121], v[58:61], v[0:3], 0
    v_mfma_f32_16x16x32_bf16 v[118:121], v[64:67], v[86:89], v[118:121]
    v_cvt_pk_bf16_f32 v108, v124, v125
    v_cvt_pk_bf16_f32 v109, v126, v127
    v_mfma_f32_16x16x32_bf16 v[118:121], v[70:73], v[102:105], v[118:121]
    v_mfma_f32_16x16x32_bf16 v[86:89], v[40:43], v[74:77], 0
    v_mfma_f32_16x16x32_bf16 v[86:89], v[46:49], v[90:93], v[86:89]
    v_mfma_f32_16x16x32_bf16 v[86:89], v[52:55], v[110:113], v[86:89]
    v_mfma_f32_16x16x32_bf16 v[0:3], v[22:25], v[78:81], 0
    v_mfma_f32_16x16x32_bf16 v[0:3], v[28:31], v[98:101], v[0:3]
    v_cndmask_b32_dpp v15, v86, v118, vcc row_ror:4 row_mask:0xf bank_mask:0xf
    v_cndmask_b32_dpp v20, v87, v119, vcc row_ror:4 row_mask:0xf bank_mask:0xf
    v_mfma_f32_16x16x32_bf16 v[0:3], v[34:37], v[114:117], v[0:3]
    v_cndmask_b32_dpp v9, v88, v120, vcc row_ror:4 row_mask:0xf bank_mask:0xf
    v_cndmask_b32_dpp v14, v89, v121, vcc row_ror:4 row_mask:0xf bank_mask:0xf
    v_mfma_f32_16x16x32_bf16 v[78:81], v[4:7], v[82:85], 0
    s_mov_b64 vcc, s[40:41]
    v_mfma_f32_16x16x32_bf16 v[78:81], v[10:13], v[94:97], v[78:81]
    v_cndmask_b32_dpp v15, v0, v15, vcc row_ror:8 row_mask:0xf bank_mask:0xf
    v_cndmask_b32_dpp v20, v1, v20, vcc row_ror:8 row_mask:0xf bank_mask:0xf
    v_mfma_f32_16x16x32_bf16 v[78:81], v[16:19], v[106:109], v[78:81]
    v_cndmask_b32_dpp v9, v2, v9, vcc row_ror:8 row_mask:0xf bank_mask:0xf
    v_cndmask_b32_dpp v14, v3, v14, vcc row_ror:8 row_mask:0xf bank_mask:0xf
    v_mfma_f32_16x16x32_bf16 v[0:3], v[4:7], a[0:3], 0
    s_mov_b64 vcc, s[44:45]
    v_mov_b64 v[76:77], v[252:253]
    v_mfma_f32_16x16x32_bf16 v[0:3], v[10:13], a[4:7], v[0:3]
    v_cndmask_b32_dpp v15, v78, v15, vcc row_ror:12 row_mask:0xf bank_mask:0xf
    v_cndmask_b32_dpp v20, v79, v20, vcc row_ror:12 row_mask:0xf bank_mask:0xf
    v_mfma_f32_16x16x32_bf16 v[0:3], v[16:19], a[8:11], v[0:3]
    v_cndmask_b32_dpp v9, v80, v9, vcc row_ror:12 row_mask:0xf bank_mask:0xf
    v_cndmask_b32_dpp v14, v81, v14, vcc row_ror:12 row_mask:0xf bank_mask:0xf
    v_mfma_f32_16x16x32_bf16 v[78:81], v[4:7], a[12:15], 0
    s_mov_b64 vcc, s[38:39]
    v_mul_f32_dpp v44, v8, v15 quad_perm:[0,0,0,0] row_mask:0xf bank_mask:0xf
    v_mul_f32_dpp v45, v8, v20 quad_perm:[1,1,1,1] row_mask:0xf bank_mask:0xf
    v_mfma_f32_16x16x32_bf16 v[78:81], v[10:13], a[16:19], v[78:81]
    v_cvt_pk_bf16_f32 v74, v0, v1
    v_cvt_pk_bf16_f32 v75, v2, v3
    v_mfma_f32_16x16x32_bf16 v[78:81], v[16:19], a[20:23], v[78:81]
    v_mul_f32_dpp v38, v8, v9 quad_perm:[2,2,2,2] row_mask:0xf bank_mask:0xf
    v_mul_f32_dpp v39, v8, v14 quad_perm:[3,3,3,3] row_mask:0xf bank_mask:0xf
    v_mfma_f32_16x16x32_bf16 v[0:3], v[4:7], a[24:27], 0
    v_max3_f32 v9, v44, v45, v38
    v_max_f32 v9, v9, v39
    v_mfma_f32_16x16x32_bf16 v[0:3], v[10:13], a[28:31], v[0:3]
    v_cvt_pk_bf16_f32 v78, v78, v79
    v_cvt_pk_bf16_f32 v79, v80, v81
    v_mfma_f32_16x16x32_bf16 v[0:3], v[16:19], a[32:35], v[0:3]
    v_mul_f32_e64 v9, -v9, v8
    v_fma_f32 v44, v44, v8, v9
    v_mfma_f32_16x16x32_bf16 v[80:83], v[4:7], a[36:39], 0
    v_fma_f32 v45, v45, v8, v9
    v_fma_f32 v38, v38, v8, v9
    v_mfma_f32_16x16x32_bf16 v[80:83], v[10:13], a[40:43], v[80:83]
    v_cvt_pk_bf16_f32 v98, v0, v1
    v_cvt_pk_bf16_f32 v99, v2, v3
    v_mfma_f32_16x16x32_bf16 v[80:83], v[16:19], a[44:47], v[80:83]
    v_fma_f32 v39, v39, v8, v9
    v_mov_b64 v[100:101], v[252:253]
    v_mfma_f32_16x16x32_bf16 v[84:87], v[4:7], a[48:51], 0
    v_exp_f32 v44, v44
    v_mfma_f32_16x16x32_bf16 v[84:87], v[10:13], a[52:55], v[84:87]
    v_cvt_pk_bf16_f32 v102, v80, v81
    v_cvt_pk_bf16_f32 v103, v82, v83
    v_mfma_f32_16x16x32_bf16 v[84:87], v[16:19], a[56:59], v[84:87]
    v_exp_f32 v45, v45
    v_mfma_f32_16x16x32_bf16 v[0:3], v[4:7], a[60:63], 0
    v_exp_f32 v38, v38
    v_mfma_f32_16x16x32_bf16 v[0:3], v[10:13], a[64:67], v[0:3]
    v_cvt_pk_bf16_f32 v104, v84, v85
    v_cvt_pk_bf16_f32 v105, v86, v87
    v_mfma_f32_16x16x32_bf16 v[0:3], v[16:19], a[68:71], v[0:3]
    v_exp_f32 v39, v39
    v_mfma_f32_16x16x32_bf16 v[80:83], v[58:61], a[0:3], 0
    v_add_f32 v9, v44, v45
    v_add_f32 v14, v38, v39
    v_mfma_f32_16x16x32_bf16 v[80:83], v[64:67], a[4:7], v[80:83]
    v_cvt_pk_bf16_f32 v108, v0, v1
    v_cvt_pk_bf16_f32 v109, v2, v3
    v_mfma_f32_16x16x32_bf16 v[80:83], v[70:73], a[8:11], v[80:83]
    v_add_f32 v9, v9, v14
    v_mul_f32_dpp v44, v8, v44 quad_perm:[0,0,0,0] row_mask:0xf bank_mask:0xf
    v_mfma_f32_16x16x32_bf16 v[84:87], v[58:61], a[12:15], 0
    v_rcp_f32 v9, v9
    v_mfma_f32_16x16x32_bf16 v[84:87], v[64:67], a[16:19], v[84:87]
    v_mul_f32_dpp v45, v8, v45 quad_perm:[1,1,1,1] row_mask:0xf bank_mask:0xf
    v_mul_f32_dpp v38, v8, v38 quad_perm:[2,2,2,2] row_mask:0xf bank_mask:0xf
    v_mfma_f32_16x16x32_bf16 v[84:87], v[70:73], a[20:23], v[84:87]
    v_mul_f32_dpp v39, v8, v39 quad_perm:[3,3,3,3] row_mask:0xf bank_mask:0xf
    v_mul_f32 v44, v44, v9
    v_mfma_f32_16x16x32_bf16 v[88:91], v[58:61], a[24:27], 0
    v_mul_f32 v45, v45, v9
    v_mul_f32 v38, v38, v9
    v_mfma_f32_16x16x32_bf16 v[88:91], v[64:67], a[28:31], v[88:91]
    v_mul_f32 v39, v39, v9
    v_cvt_pk_bf16_f32 v32, v44, v45
    v_mfma_f32_16x16x32_bf16 v[88:91], v[70:73], a[32:35], v[88:91]
    v_cvt_pk_bf16_f32 v33, v38, v39
    v_and_b32_dpp v2, v32, v225 row_ror:4 row_mask:0xf bank_mask:0xf
    v_mfma_f32_16x16x32_bf16 v[92:95], v[58:61], a[36:39], 0
    v_and_b32_dpp v3, v33, v225 row_ror:4 row_mask:0xf bank_mask:0xf
    v_cvt_pk_bf16_f32 v80, v80, v81
    v_mfma_f32_16x16x32_bf16 v[92:95], v[64:67], a[40:43], v[92:95]
    v_cvt_pk_bf16_f32 v81, v82, v83
    v_mov_b64 v[8:9], v[2:3]
    v_mfma_f32_16x16x32_bf16 v[92:95], v[70:73], a[44:47], v[92:95]
    v_cvt_pk_bf16_f32 v84, v84, v85
    v_cvt_pk_bf16_f32 v85, v86, v87
    v_mfma_f32_16x16x32_bf16 v[110:113], v[58:61], a[48:51], 0
    v_cvt_pk_bf16_f32 v86, v88, v89
    v_cvt_pk_bf16_f32 v87, v90, v91
    v_mfma_f32_16x16x32_bf16 v[110:113], v[64:67], a[52:55], v[110:113]
    v_mov_b64 v[14:15], v[2:3]
    v_cvt_pk_bf16_f32 v90, v92, v93
    v_mfma_f32_16x16x32_bf16 v[110:113], v[70:73], a[56:59], v[110:113]
    v_cvt_pk_bf16_f32 v91, v94, v95
    v_mov_b64 v[106:107], v[252:253]
    v_mfma_f32_16x16x32_bf16 v[114:117], v[58:61], a[60:63], 0
    v_mov_b64 v[20:21], v[2:3]
    v_mov_b64 v[82:83], v[252:253]
    v_mfma_f32_16x16x32_bf16 v[114:117], v[64:67], a[64:67], v[114:117]
    v_cvt_pk_bf16_f32 v92, v110, v111
    v_cvt_pk_bf16_f32 v93, v112, v113
    v_mfma_f32_16x16x32_bf16 v[114:117], v[70:73], a[68:71], v[114:117]
    v_mov_b64 v[88:89], v[252:253]
    v_mov_b64 v[94:95], v[252:253]
    v_mfma_f32_16x16x32_bf16 v[110:113], v[74:77], v[2:5], 0
    v_fmac_f32_dpp v26, v27, v44 quad_perm:[0,0,0,0] row_mask:0xf bank_mask:0xf
    v_fmac_f32_dpp v26, v27, v45 quad_perm:[1,1,1,1] row_mask:0xf bank_mask:0xf
    v_mfma_f32_16x16x32_bf16 v[118:121], v[76:79], v[6:9], 0
    v_cvt_pk_bf16_f32 v96, v114, v115
    v_cvt_pk_bf16_f32 v97, v116, v117
    v_mfma_f32_16x16x32_bf16 v[0:3], v[98:101], v[8:11], 0
    v_cvt_pk_bf16_f32 v76, v110, v111
    v_cvt_pk_bf16_f32 v77, v112, v113
    v_mfma_f32_16x16x32_bf16 v[110:113], v[100:103], v[12:15], 0
    v_cvt_pk_bf16_f32 v78, v118, v119
    v_cvt_pk_bf16_f32 v79, v120, v121
    v_mfma_f32_16x16x32_bf16 v[8:11], v[104:107], v[14:17], 0
    ds_write_b128 v209, v[76:79]
    v_mfma_f32_16x16x32_bf16 v[4:7], v[106:109], v[18:21], 0
    v_cvt_pk_bf16_f32 v98, v0, v1
    v_cvt_pk_bf16_f32 v99, v2, v3
    v_mfma_f32_16x16x32_bf16 v[0:3], v[40:43], a[0:3], 0
    v_cvt_pk_bf16_f32 v100, v110, v111
    v_cvt_pk_bf16_f32 v101, v112, v113
    v_mfma_f32_16x16x32_bf16 v[0:3], v[46:49], a[4:7], v[0:3]
    ds_write_b128 v209, v[98:101] offset:64
    v_mfma_f32_16x16x32_bf16 v[0:3], v[52:55], a[8:11], v[0:3]
    v_cvt_pk_bf16_f32 v102, v8, v9
    v_cvt_pk_bf16_f32 v103, v10, v11
    v_mfma_f32_16x16x32_bf16 v[14:17], v[40:43], a[12:15], 0
    v_cvt_pk_bf16_f32 v104, v4, v5
    v_cvt_pk_bf16_f32 v105, v6, v7
    v_mfma_f32_16x16x32_bf16 v[14:17], v[46:49], a[16:19], v[14:17]
    ds_write_b128 v209, v[102:105] offset:128
    v_mfma_f32_16x16x32_bf16 v[14:17], v[52:55], a[20:23], v[14:17]
    v_cvt_pk_bf16_f32 v0, v0, v1
    v_cvt_pk_bf16_f32 v1, v2, v3
    v_mfma_f32_16x16x32_bf16 v[10:13], v[40:43], a[24:27], 0
    v_mov_b64 v[2:3], v[252:253]
    v_mov_b64 v[8:9], v[252:253]
    v_mfma_f32_16x16x32_bf16 v[10:13], v[46:49], a[28:31], v[10:13]
    v_cvt_pk_bf16_f32 v4, v14, v15
    v_cvt_pk_bf16_f32 v5, v16, v17
    v_mfma_f32_16x16x32_bf16 v[10:13], v[52:55], a[32:35], v[10:13]
    v_fmac_f32_dpp v26, v27, v38 quad_perm:[2,2,2,2] row_mask:0xf bank_mask:0xf
    v_fmac_f32_dpp v26, v27, v39 quad_perm:[3,3,3,3] row_mask:0xf bank_mask:0xf
    v_mfma_f32_16x16x32_bf16 v[16:19], v[40:43], a[36:39], 0
    v_and_b32 v56, v32, v225
    v_and_b32 v57, v33, v225
    v_mfma_f32_16x16x32_bf16 v[16:19], v[46:49], a[40:43], v[16:19]
    v_mov_b64 v[62:63], v[56:57]
    v_cvt_pk_bf16_f32 v6, v10, v11
    v_mfma_f32_16x16x32_bf16 v[16:19], v[52:55], a[44:47], v[16:19]
    v_cvt_pk_bf16_f32 v7, v12, v13
    v_mov_b64 v[68:69], v[56:57]
    v_mfma_f32_16x16x32_bf16 v[106:109], v[40:43], a[48:51], 0
    v_mov_b64 v[74:75], v[56:57]
    v_mov_b64 v[14:15], v[252:253]
    v_mfma_f32_16x16x32_bf16 v[106:109], v[46:49], a[52:55], v[106:109]
    v_cvt_pk_bf16_f32 v10, v16, v17
    v_cvt_pk_bf16_f32 v11, v18, v19
    v_mfma_f32_16x16x32_bf16 v[106:109], v[52:55], a[56:59], v[106:109]
    v_mul_f32 v114, v26, v26
    v_mfma_f32_16x16x32_bf16 v[110:113], v[40:43], a[60:63], 0
    v_mfma_f32_16x16x32_bf16 v[110:113], v[46:49], a[64:67], v[110:113]
    v_cvt_pk_bf16_f32 v12, v106, v107
    v_cvt_pk_bf16_f32 v13, v108, v109
    v_mfma_f32_16x16x32_bf16 v[110:113], v[52:55], a[68:71], v[110:113]
    v_mfma_f32_16x16x32_bf16 v[18:21], v[76:79], v[76:79], 0
    v_mfma_f32_16x16x32_bf16 v[18:21], v[98:101], v[98:101], v[18:21]
    v_cvt_pk_bf16_f32 v16, v110, v111
    v_cvt_pk_bf16_f32 v17, v112, v113
    v_mfma_f32_16x16x32_bf16 v[18:21], v[102:105], v[102:105], v[18:21]
    v_mfma_f32_16x16x32_bf16 v[106:109], v[80:83], v[56:59], 0
    v_mfma_f32_16x16x32_bf16 v[110:113], v[82:85], v[60:63], 0
    v_cndmask_b32_e64 v115, v18, v19, s[32:33]
    v_cndmask_b32_e64 v115, v115, v20, s[34:35]
    v_mfma_f32_16x16x32_bf16 v[56:59], v[86:89], v[62:65], 0
    v_cvt_pk_bf16_f32 v80, v106, v107
    v_cvt_pk_bf16_f32 v81, v108, v109
    v_mfma_f32_16x16x32_bf16 v[106:109], v[88:91], v[66:69], 0
    v_cvt_pk_bf16_f32 v82, v110, v111
    v_cvt_pk_bf16_f32 v83, v112, v113
    v_mfma_f32_16x16x32_bf16 v[64:67], v[92:95], v[68:71], 0
    ds_write_b128 v232, v[80:83]
    v_mfma_f32_16x16x32_bf16 v[60:63], v[94:97], v[72:75], 0
    v_cvt_pk_bf16_f32 v84, v56, v57
    v_cvt_pk_bf16_f32 v85, v58, v59
    v_mfma_f32_16x16x32_bf16 v[56:59], a[144:147], v[76:79], 0
    v_cvt_pk_bf16_f32 v86, v106, v107
    v_cvt_pk_bf16_f32 v87, v108, v109
    v_mfma_f32_16x16x32_bf16 v[56:59], a[148:151], v[98:101], v[56:59]
    ds_write_b128 v232, v[84:87] offset:64
    v_mfma_f32_16x16x32_bf16 v[56:59], a[152:155], v[102:105], v[56:59]
    v_cvt_pk_bf16_f32 v88, v64, v65
    v_cvt_pk_bf16_f32 v89, v66, v67
    v_mfma_f32_16x16x32_bf16 v[64:67], a[156:159], v[76:79], 0
    v_cvt_pk_bf16_f32 v90, v60, v61
    v_cvt_pk_bf16_f32 v91, v62, v63
    v_mfma_f32_16x16x32_bf16 v[64:67], a[160:163], v[98:101], v[64:67]
    ds_write_b128 v232, v[88:91] offset:128
    v_mfma_f32_16x16x32_bf16 v[64:67], a[164:167], v[102:105], v[64:67]
    v_cvt_pk_bf16_f32 v18, v56, v57
    v_cvt_pk_bf16_f32 v19, v58, v59
    v_mfma_f32_16x16x32_bf16 v[56:59], a[168:171], v[76:79], 0
    v_cndmask_b32_e64 v115, v115, v21, s[36:37]
    v_add_u32 v232, 37632, v232
    v_mfma_f32_16x16x32_bf16 v[56:59], a[172:175], v[98:101], v[56:59]
    v_cvt_pk_bf16_f32 v20, v64, v65
    v_cvt_pk_bf16_f32 v21, v66, v67
    v_mfma_f32_16x16x32_bf16 v[56:59], a[176:179], v[102:105], v[56:59]
    ds_write_b128 v209, v[18:21] offset:768
    v_mfma_f32_16x16x32_bf16 v[18:21], a[180:183], v[76:79], 0
    v_cvt_pk_bf16_f32 v60, v56, v57
    v_cvt_pk_bf16_f32 v61, v58, v59
    v_mfma_f32_16x16x32_bf16 v[18:21], a[184:187], v[98:101], v[18:21]
    v_mfma_f32_16x16x32_bf16 v[18:21], a[188:191], v[102:105], v[18:21]
    v_mfma_f32_16x16x32_bf16 v[56:59], a[192:195], v[76:79], 0
    v_mfma_f32_16x16x32_bf16 v[56:59], a[196:199], v[98:101], v[56:59]
    v_cvt_pk_bf16_f32 v62, v18, v19
    v_cvt_pk_bf16_f32 v63, v20, v21
    v_mfma_f32_16x16x32_bf16 v[56:59], a[200:203], v[102:105], v[56:59]
    ds_write_b128 v209, v[60:63] offset:832
    v_mfma_f32_16x16x32_bf16 v[18:21], a[204:207], v[76:79], 0
    v_cvt_pk_bf16_f32 v56, v56, v57
    v_cvt_pk_bf16_f32 v57, v58, v59
    v_mfma_f32_16x16x32_bf16 v[18:21], a[208:211], v[98:101], v[18:21]
    v_mfma_f32_16x16x32_bf16 v[18:21], a[212:215], v[102:105], v[18:21]
    v_mfma_f32_16x16x32_bf16 v[66:69], v[22:25], a[0:3], 0
    v_mov_b64 v[60:61], v[252:253]
    v_mfma_f32_16x16x32_bf16 v[66:69], v[28:31], a[4:7], v[66:69]
    v_cvt_pk_bf16_f32 v58, v18, v19
    v_cvt_pk_bf16_f32 v59, v20, v21
    v_mfma_f32_16x16x32_bf16 v[66:69], v[34:37], a[8:11], v[66:69]
    ds_write_b128 v209, v[56:59] offset:896
    v_mfma_f32_16x16x32_bf16 v[62:65], v[22:25], a[12:15], 0
    v_cvt_pk_bf16_f32 v58, v66, v67
    v_cvt_pk_bf16_f32 v59, v68, v69
    v_mfma_f32_16x16x32_bf16 v[62:65], v[28:31], a[16:19], v[62:65]
    v_mfma_f32_16x16x32_bf16 v[62:65], v[34:37], a[20:23], v[62:65]
    v_mfma_f32_16x16x32_bf16 v[18:21], v[22:25], a[24:27], 0
    v_and_b32_dpp v38, v32, v225 row_ror:12 row_mask:0xf bank_mask:0xf
    v_and_b32_dpp v39, v33, v225 row_ror:12 row_mask:0xf bank_mask:0xf
    v_mfma_f32_16x16x32_bf16 v[18:21], v[28:31], a[28:31], v[18:21]
    v_mov_b64 v[44:45], v[38:39]
    v_cvt_pk_bf16_f32 v62, v62, v63
    v_mfma_f32_16x16x32_bf16 v[18:21], v[34:37], a[32:35], v[18:21]
    v_cvt_pk_bf16_f32 v63, v64, v65
    v_mov_b64 v[50:51], v[38:39]
    v_mfma_f32_16x16x32_bf16 v[68:71], v[22:25], a[36:39], 0
    v_mov_b64 v[56:57], v[38:39]
    v_mov_b64 v[66:67], v[252:253]
    v_mfma_f32_16x16x32_bf16 v[68:71], v[28:31], a[40:43], v[68:71]
    v_cvt_pk_bf16_f32 v64, v18, v19
    v_cvt_pk_bf16_f32 v65, v20, v21
    v_mfma_f32_16x16x32_bf16 v[68:71], v[34:37], a[44:47], v[68:71]
    v_mfma_f32_16x16x32_bf16 v[106:109], v[22:25], a[48:51], 0
    v_mov_b64 v[72:73], v[252:253]
    v_mfma_f32_16x16x32_bf16 v[106:109], v[28:31], a[52:55], v[106:109]
    v_cvt_pk_bf16_f32 v68, v68, v69
    v_cvt_pk_bf16_f32 v69, v70, v71
    v_mfma_f32_16x16x32_bf16 v[106:109], v[34:37], a[56:59], v[106:109]
    v_mfma_f32_16x16x32_bf16 v[92:95], v[22:25], a[60:63], 0
    v_and_b32_dpp v20, v32, v225 row_ror:8 row_mask:0xf bank_mask:0xf
    v_and_b32_dpp v21, v33, v225 row_ror:8 row_mask:0xf bank_mask:0xf
    v_mfma_f32_16x16x32_bf16 v[92:95], v[28:31], a[64:67], v[92:95]
    v_cvt_pk_bf16_f32 v70, v106, v107
    v_cvt_pk_bf16_f32 v71, v108, v109
    v_mfma_f32_16x16x32_bf16 v[92:95], v[34:37], a[68:71], v[92:95]
    v_mov_b64 v[26:27], v[20:21]
    v_mov_b64 v[32:33], v[20:21]
    v_mfma_f32_16x16x32_bf16 v[110:113], v[0:3], v[38:41], 0
    v_mov_b64 v[38:39], v[20:21]
    v_mfma_f32_16x16x32_bf16 v[106:109], v[2:5], v[42:45], 0
    v_cvt_pk_bf16_f32 v74, v92, v93
    v_cvt_pk_bf16_f32 v75, v94, v95
    v_mfma_f32_16x16x32_bf16 v[40:43], v[6:9], v[44:47], 0
    v_cvt_pk_bf16_f32 v44, v110, v111
    v_cvt_pk_bf16_f32 v45, v112, v113
    v_mfma_f32_16x16x32_bf16 v[92:95], v[8:11], v[48:51], 0
    v_cvt_pk_bf16_f32 v46, v106, v107
    v_cvt_pk_bf16_f32 v47, v108, v109
    v_mfma_f32_16x16x32_bf16 v[4:7], v[12:15], v[50:53], 0
    ds_write_b128 v233, v[44:47]
    v_mfma_f32_16x16x32_bf16 v[0:3], v[14:17], v[54:57], 0
    v_cvt_pk_bf16_f32 v52, v40, v41
    v_cvt_pk_bf16_f32 v53, v42, v43
    v_mfma_f32_16x16x32_bf16 v[40:43], v[80:83], v[80:83], 0
    v_cvt_pk_bf16_f32 v54, v92, v93
    v_cvt_pk_bf16_f32 v55, v94, v95
    v_mfma_f32_16x16x32_bf16 v[40:43], v[84:87], v[84:87], v[40:43]
    ds_write_b128 v233, v[52:55] offset:64
    v_mfma_f32_16x16x32_bf16 v[40:43], v[88:91], v[88:91], v[40:43]
    v_cvt_pk_bf16_f32 v56, v4, v5
    v_cvt_pk_bf16_f32 v57, v6, v7
    v_mfma_f32_16x16x32_bf16 v[10:13], v[58:61], v[20:23], 0
    v_cvt_pk_bf16_f32 v58, v0, v1
    v_cvt_pk_bf16_f32 v59, v2, v3
    v_mfma_f32_16x16x32_bf16 v[18:21], v[60:63], v[24:27], 0
    ds_read_b128 v[0:3], v231 offset:9216
    v_cndmask_b32_e64 v92, v40, v41, s[32:33]
    v_mfma_f32_16x16x32_bf16 v[88:91], v[64:67], v[26:29], 0
    ds_read_b128 v[4:7], v231 offset:11264
    v_cvt_pk_bf16_f32 v48, v10, v11
    v_mfma_f32_16x16x32_bf16 v[84:87], v[66:69], v[30:33], 0
    ds_read_b128 v[8:11], v231 offset:12288
    v_cvt_pk_bf16_f32 v49, v12, v13
    v_mfma_f32_16x16x32_bf16 v[80:83], v[70:73], v[32:35], 0
    ds_read_b128 v[12:15], v231 offset:14336
    v_cvt_pk_bf16_f32 v50, v18, v19
    v_mfma_f32_16x16x32_bf16 v[64:67], v[72:75], v[36:39], 0
    s_waitcnt lgkmcnt(14)
    ds_read_b128 v[16:19], v231 offset:16384
    v_cvt_pk_bf16_f32 v51, v20, v21
    v_mfma_f32_16x16x32_bf16 v[60:63], v[44:47], v[44:47], 0
    s_waitcnt lgkmcnt(14)
    ds_read_b128 v[20:23], v231 offset:13312
    v_cvt_pk_bf16_f32 v44, v88, v89
    v_mfma_f32_16x16x32_bf16 v[60:63], v[52:55], v[52:55], v[60:63]
    s_waitcnt lgkmcnt(14)
    ds_read_b128 v[24:27], v231 offset:15360
    v_cvt_pk_bf16_f32 v45, v90, v91
    v_mfma_f32_16x16x32_bf16 v[60:63], v[56:59], v[56:59], v[60:63]
    s_waitcnt lgkmcnt(14)
    ds_read_b128 v[28:31], v231 offset:17408
    v_cvt_pk_bf16_f32 v46, v84, v85
    v_mfma_f32_16x16x32_bf16 v[36:39], a[216:219], v[76:79], 0
    s_waitcnt lgkmcnt(14)
    ds_write_b128 v233, v[56:59] offset:128
    v_mfma_f32_16x16x32_bf16 v[36:39], a[220:223], v[98:101], v[36:39]
    v_cvt_pk_bf16_f32 v47, v86, v87
    v_cvt_pk_bf16_f32 v56, v80, v81
    v_mfma_f32_16x16x32_bf16 v[36:39], a[224:227], v[102:105], v[36:39]
    s_waitcnt lgkmcnt(14)
    ds_write_b128 v234, v[48:51]
    v_mfma_f32_16x16x32_bf16 v[32:35], a[228:231], v[76:79], 0
    v_cvt_pk_bf16_f32 v57, v82, v83
    v_cvt_pk_bf16_f32 v58, v64, v65
    v_mfma_f32_16x16x32_bf16 v[32:35], a[232:235], v[98:101], v[32:35]
    s_waitcnt lgkmcnt(14)
    ds_write_b128 v234, v[44:47] offset:64
    v_mfma_f32_16x16x32_bf16 v[32:35], a[236:239], v[102:105], v[32:35]
    v_cvt_pk_bf16_f32 v59, v66, v67
    v_cndmask_b32_e64 v60, v60, v61, s[32:33]
    v_mfma_f32_16x16x32_bf16 v[52:55], v[48:51], v[48:51], 0
    v_cndmask_b32_e64 v60, v60, v62, s[34:35]
    v_cndmask_b32_e64 v60, v60, v63, s[36:37]
    v_mfma_f32_16x16x32_bf16 v[52:55], v[44:47], v[44:47], v[52:55]
    s_waitcnt lgkmcnt(14)
    ds_write_b128 v234, v[56:59] offset:128
    v_mfma_f32_16x16x32_bf16 v[52:55], v[56:59], v[56:59], v[52:55]
    v_cndmask_b32_e64 v92, v92, v42, s[34:35]
    v_cndmask_b32_e64 v92, v92, v43, s[36:37]
    v_mfma_f32_16x16x32_bf16 v[40:43], a[240:243], v[76:79], 0
    v_cndmask_b32_dpp v48, v60, v92, vcc row_ror:4 row_mask:0xf bank_mask:0xf
    s_mov_b64 vcc, s[40:41]
    v_mfma_f32_16x16x32_bf16 v[40:43], a[244:247], v[98:101], v[40:43]
    v_cndmask_b32_e64 v49, v52, v53, s[32:33]
    v_cndmask_b32_e64 v49, v49, v54, s[34:35]
    v_mfma_f32_16x16x32_bf16 v[40:43], a[248:251], v[102:105], v[40:43]
    v_cndmask_b32_e64 v49, v49, v55, s[36:37]
    v_cvt_pk_bf16_f32 v36, v36, v37
    v_mfma_f32_16x16x32_bf16 v[44:47], a[252:255], v[76:79], 0
    s_waitcnt lgkmcnt(11)
    v_cndmask_b32_dpp v48, v49, v48, vcc row_ror:8 row_mask:0xf bank_mask:0xf
    s_mov_b64 vcc, s[44:45]
    v_mfma_f32_16x16x32_bf16 v[44:47], v[0:3], v[98:101], v[44:47]
    s_waitcnt lgkmcnt(10)
    v_cndmask_b32_dpp v48, v115, v48, vcc row_ror:12 row_mask:0xf bank_mask:0xf
    v_fmamk_f32 v114, v114, 0xbc2aaaab, v48
    v_mfma_f32_16x16x32_bf16 v[44:47], v[4:7], v[102:105], v[44:47]
    s_waitcnt lgkmcnt(9)
    v_add_f32_e64 v114, |v114|, s51
    v_cvt_pk_bf16_f32 v37, v38, v39
    v_mfma_f32_16x16x32_bf16 v[0:3], v[8:11], v[76:79], 0
    ds_write_b64 v208, v[36:37] offset:1536
    s_waitcnt lgkmcnt(9)
    v_mfma_f32_16x16x32_bf16 v[0:3], v[12:15], v[98:101], v[0:3]
    s_waitcnt lgkmcnt(8)
    v_rsq_f32 v4, v114
    v_mfma_f32_16x16x32_bf16 v[0:3], v[16:19], v[102:105], v[0:3]
    ds_write_b32 v235, v4
    s_waitcnt lgkmcnt(8)
    v_mfma_f32_16x16x32_bf16 v[4:7], v[20:23], v[76:79], 0
    s_waitcnt lgkmcnt(7)
    v_cvt_pk_bf16_f32 v8, v32, v33
    v_cvt_pk_bf16_f32 v9, v34, v35
    v_mfma_f32_16x16x32_bf16 v[4:7], v[24:27], v[98:101], v[4:7]
    ds_write_b64 v208, v[8:9] offset:1568
    s_waitcnt lgkmcnt(7)
    v_mfma_f32_16x16x32_bf16 v[4:7], v[28:31], v[102:105], v[4:7]
    v_cvt_pk_bf16_f32 v8, v40, v41
    v_cvt_pk_bf16_f32 v9, v42, v43
    v_cvt_pk_bf16_f32 v10, v44, v45
    v_cvt_pk_bf16_f32 v11, v46, v47
    v_cvt_pk_bf16_f32 v0, v0, v1
    v_cvt_pk_bf16_f32 v1, v2, v3
    v_add_u32 v235, 37632, v235
    v_cvt_pk_bf16_f32 v2, v4, v5
    v_cvt_pk_bf16_f32 v3, v6, v7
    v_add_u32 v233, 37632, v233
    v_add_u32 v234, 37632, v234
    v_cndmask_b32_e64 v235, v128, v235, s[44:45]
    ds_write_b64 v208, v[8:9] offset:1600
    ds_write_b64 v208, v[10:11] offset:1632
    ds_write_b64 v208, v[0:1] offset:1664
    ds_write_b64 v208, v[2:3] offset:1696
    s_sub_u32 s22, s21, 1
    s_mov_b32 s62, -4
    s_mov_b32 s60, 2320
    s_mov_b32 s61, 2320
    s_waitcnt vmcnt(0) lgkmcnt(0)
    s_barrier
    ds_read_b128 v[0:3], v226 offset:0
    ds_read_b128 v[8:11], v226 offset:64
    ds_read_b128 v[4:7], v226 offset:128
    s_waitcnt lgkmcnt(0)
.p2align 6
L_loop:
    v_mfma_f32_16x16x32_bf16 v[12:15], a[144:147], v[0:3], 0
    s_sub_u32 s58, s29, s28
    ds_read_b128 v[16:19], v230 offset:6144
    ds_read_b128 v[74:77], v226 offset:3072
    v_mfma_f32_16x16x32_bf16 v[12:15], a[148:151], v[8:11], v[12:15]
    s_subb_u32 s59, s58, 0
    ds_read_b128 v[70:73], v226 offset:3136
    v_mov_b32_dpp v150, v158 quad_perm:[0,1,2,3] row_mask:0xf bank_mask:0x2
    v_mfma_f32_16x16x32_bf16 v[12:15], a[152:155], v[4:7], v[12:15]
    s_sub_u32 s56, s30, s29
    ds_read_b128 v[66:69], v226 offset:3200
    v_mov_b32_dpp v151, v159 quad_perm:[0,1,2,3] row_mask:0xf bank_mask:0x2
    v_mfma_f32_16x16x32_bf16 v[20:23], a[156:159], v[0:3], 0
    s_subb_u32 s57, s56, 0
    ds_read_b128 v[98:101], v226 offset:6144
    v_mov_b32_dpp v152, v160 quad_perm:[0,1,2,3] row_mask:0xf bank_mask:0x2
    v_mfma_f32_16x16x32_bf16 v[20:23], a[160:163], v[8:11], v[20:23]
    s_add_u32 s50, s30, s43
    ds_read_b128 v[94:97], v226 offset:6208
    v_cvt_pk_bf16_f32 v46, v12, v13
    v_mfma_f32_16x16x32_bf16 v[20:23], a[164:167], v[4:7], v[20:23]
    s_add_u32 m0, s50, 0
    ds_read_b128 v[90:93], v226 offset:6272
    v_cvt_pk_bf16_f32 v47, v14, v15
    v_mfma_f32_16x16x32_bf16 v[24:27], a[168:171], v[0:3], 0
    s_mov_b64 vcc, s[38:39]
    ds_read_b128 v[12:15], v222
    v_mov_b32_dpp v153, v161 quad_perm:[0,1,2,3] row_mask:0xf bank_mask:0x2
    v_mfma_f32_16x16x32_bf16 v[24:27], a[172:175], v[8:11], v[24:27]
    s_mov_b32 s46, s28
    ds_read_b128 v[78:81], v222 offset:64
    v_cvt_pk_bf16_f32 v48, v20, v21
    v_mfma_f32_16x16x32_bf16 v[24:27], a[176:179], v[4:7], v[24:27]
    s_mov_b32 s28, s29
    ds_read_b32 v172, v228
    v_cvt_pk_bf16_f32 v49, v22, v23
    v_mfma_f32_16x16x32_bf16 v[50:53], a[180:183], v[0:3], 0
    s_mov_b32 s29, s30
    ds_read_b128 v[82:85], v222 offset:128
    v_mov_b32_dpp v150, v154 quad_perm:[0,1,2,3] row_mask:0xf bank_mask:0x4
    v_mfma_f32_16x16x32_bf16 v[50:53], a[184:187], v[8:11], v[50:53]
    s_mov_b32 s30, s46
    ds_read_b128 v[54:57], v227
    v_cvt_pk_bf16_f32 v86, v24, v25
    v_mfma_f32_16x16x32_bf16 v[50:53], a[188:191], v[4:7], v[50:53]
    ds_read_b128 v[58:61], v227 offset:64
    v_cvt_pk_bf16_f32 v87, v26, v27
    v_mfma_f32_16x16x32_bf16 v[20:23], a[192:195], v[0:3], 0
    ds_read_b128 v[62:65], v227 offset:128
    v_mov_b32_dpp v151, v155 quad_perm:[0,1,2,3] row_mask:0xf bank_mask:0x4
    v_mfma_f32_16x16x32_bf16 v[20:23], a[196:199], v[8:11], v[20:23]
    ds_read_b32 v208, v224
    v_cvt_pk_bf16_f32 v88, v50, v51
    v_mfma_f32_16x16x32_bf16 v[20:23], a[200:203], v[4:7], v[20:23]
    s_waitcnt lgkmcnt(14)
    buffer_store_dwordx4 v[16:19], v218, s[8:11], s27 offen nt
    v_mfma_f32_16x16x32_bf16 v[24:27], a[204:207], v[0:3], 0
    ds_read_b128 v[164:167], v230 offset:7168
    v_cvt_pk_bf16_f32 v89, v52, v53
    v_mfma_f32_16x16x32_bf16 v[24:27], a[208:211], v[8:11], v[24:27]
    v_mov_b32_dpp v152, v156 quad_perm:[0,1,2,3] row_mask:0xf bank_mask:0x4
    v_mov_b32_dpp v153, v157 quad_perm:[0,1,2,3] row_mask:0xf bank_mask:0x4
    v_mfma_f32_16x16x32_bf16 v[24:27], a[212:215], v[4:7], v[24:27]
    s_waitcnt lgkmcnt(14)
    v_mul_f32 v150, v150, v40
    v_mul_f32 v151, v151, v41
    v_mfma_f32_16x16x32_bf16 v[160:163], a[144:147], v[74:77], 0
    s_waitcnt lgkmcnt(13)
    v_mul_f32 v152, v152, v42
    v_mul_f32 v153, v153, v43
    v_mfma_f32_16x16x32_bf16 v[160:163], a[148:151], v[70:73], v[160:163]
    s_waitcnt lgkmcnt(12)
    v_mul_f32 v182, v182, v45
    v_max3_f32 v173, v150, v151, v152
    v_mfma_f32_16x16x32_bf16 v[160:163], a[152:155], v[66:69], v[160:163]
    v_max3_f32 v173, v173, v153, v182
    v_cvt_pk_bf16_f32 v168, v20, v21
    v_mfma_f32_16x16x32_bf16 v[50:53], a[156:159], v[74:77], 0
    v_max_f32_dpp v173, v173, v173 row_ror:4 row_mask:0xf bank_mask:0xf
    v_cvt_pk_bf16_f32 v169, v22, v23
    v_mfma_f32_16x16x32_bf16 v[50:53], a[160:163], v[70:73], v[50:53]
    v_max_f32_dpp v173, v173, v173 row_ror:8 row_mask:0xf bank_mask:0xf
    v_mov_b32 v16, v173
    v_mfma_f32_16x16x32_bf16 v[50:53], a[164:167], v[66:69], v[50:53]
    v_cvt_pk_bf16_f32 v170, v24, v25
    v_cvt_pk_bf16_f32 v171, v26, v27
    v_mfma_f32_16x16x32_bf16 v[20:23], v[0:3], v[46:49], 0
    v_permlane32_swap_b32 v173, v16
    v_mfma_f32_16x16x32_bf16 v[20:23], v[8:11], v[86:89], v[20:23]
    v_max_f32 v173, v173, v16
    v_mov_b32 v16, v173
    v_mfma_f32_16x16x32_bf16 v[20:23], v[4:7], v[168:171], v[20:23]
    v_cvt_pk_bf16_f32 v44, v160, v161
    v_permlane16_swap_b32 v173, v16
    v_mfma_f32_16x16x32_bf16 v[24:27], v[74:77], v[46:49], 0
    v_max_f32 v173, v173, v16
    v_mul_f32_e64 v173, -v173, v45
    v_mfma_f32_16x16x32_bf16 v[24:27], v[70:73], v[86:89], v[24:27]
    s_waitcnt lgkmcnt(0)
    buffer_store_dwordx4 v[164:167], v219, s[8:11], s27 offen nt
    v_mfma_f32_16x16x32_bf16 v[24:27], v[66:69], v[168:171], v[24:27]
    ds_read_b128 v[158:161], v230 offset:8192
    v_fma_f32 v150, v150, v45, v173
    v_mfma_f32_16x16x32_bf16 v[16:19], v[98:101], v[46:49], 0
    v_fma_f32 v151, v151, v45, v173
    v_fma_f32 v152, v152, v45, v173
    v_mfma_f32_16x16x32_bf16 v[16:19], v[94:97], v[86:89], v[16:19]
    v_fma_f32 v153, v153, v45, v173
    v_exp_f32 v150, v150
    v_mfma_f32_16x16x32_bf16 v[16:19], v[90:93], v[168:171], v[16:19]
    v_exp_f32 v151, v151
    v_mfma_f32_16x16x32_bf16 v[154:157], v[12:15], v[46:49], 0
    v_exp_f32 v152, v152
    v_mfma_f32_16x16x32_bf16 v[154:157], v[78:81], v[86:89], v[154:157]
    v_exp_f32 v153, v153
    v_mfma_f32_16x16x32_bf16 v[154:157], v[82:85], v[168:171], v[154:157]
    v_add_f32 v46, v150, v151
    v_add_f32 v47, v152, v153
    v_add_f32 v46, v46, v47
    v_fma_f32 v182, v182, v45, v173
    v_exp_f32 v182, v182
    v_add_f32_dpp v47, v46, v46 row_shl:4 row_mask:0xf bank_mask:0xf bound_ctrl:0
    v_add_f32_dpp v46, v46, v47 row_shl:8 row_mask:0xf bank_mask:0xf bound_ctrl:0
    v_mov_b32 v47, v46
    v_mul_f32 v150, v150, v40
    v_mul_f32 v151, v151, v41
    v_permlane32_swap_b32 v46, v47
    v_add_f32 v46, v46, v47
    v_mov_b32 v47, v46
    v_mul_f32 v152, v152, v42
    v_mul_f32 v153, v153, v43
    v_permlane16_swap_b32 v46, v47
    v_add_f32 v46, v46, v47
    v_add_f32 v46, v46, v182
    v_rcp_f32 v46, v46
    v_mul_f32 v182, v182, v45
    v_cvt_pk_bf16_f32 v45, v162, v163
    v_mul_f32_dpp v150, v46, v150 row_newbcast:0 row_mask:0xf bank_mask:0xf
    v_mul_f32_dpp v151, v46, v151 row_newbcast:0 row_mask:0xf bank_mask:0xf
    v_mul_f32_dpp v152, v46, v152 row_newbcast:0 row_mask:0xf bank_mask:0xf
    v_mul_f32_dpp v153, v46, v153 row_newbcast:0 row_mask:0xf bank_mask:0xf
    v_cvt_pk_bf16_f32 v40, v150, v151
    v_cvt_pk_bf16_f32 v41, v152, v153
    v_mul_f32_dpp v182, v46, v182 row_newbcast:0 row_mask:0xf bank_mask:0xf
    v_mov_b32_dpp v42, v40 row_shl:4 row_mask:0xf bank_mask:0xf bound_ctrl:0
    v_mov_b32_dpp v43, v41 row_shl:4 row_mask:0xf bank_mask:0xf bound_ctrl:0
    v_cvt_pk_bf16_f32 v182, v182, v182
    v_mov_b32_dpp v86, v40 row_shl:8 row_mask:0xf bank_mask:0xf bound_ctrl:0
    v_mfma_f32_16x16x32_bf16 v[150:153], v[102:105], v[40:43], 0
    s_waitcnt lgkmcnt(0)
    buffer_store_dwordx4 v[158:161], v220, s[8:11], s27 offen nt
    v_mov_b32_dpp v87, v41 row_shl:8 row_mask:0xf bank_mask:0xf bound_ctrl:0
    v_and_b32 v88, v182, v236
    v_and_b32 v89, v182, v237
    v_cvt_pk_bf16_f32 v46, v50, v51
    v_cvt_pk_bf16_f32 v47, v52, v53
    v_mfma_f32_16x16x32_bf16 v[150:153], v[114:117], v[86:89], v[150:153]
    v_mul_f32 v20, v20, v54
    v_mul_f32 v21, v21, v55
    v_mfma_f32_16x16x32_bf16 v[150:153], v[252:255], v[36:39], v[150:153]
    v_mul_f32 v22, v22, v56
    v_mul_f32 v23, v23, v57
    v_mfma_f32_16x16x32_bf16 v[50:53], v[106:109], v[40:43], 0
    v_mul_f32 v24, v24, v58
    v_mul_f32 v25, v25, v59
    v_mfma_f32_16x16x32_bf16 v[50:53], v[122:125], v[86:89], v[50:53]
    v_cvt_pk_bf16_f32 v48, v150, v151
    v_cvt_pk_bf16_f32 v49, v152, v153
    v_mfma_f32_16x16x32_bf16 v[50:53], v[250:253], v[36:39], v[50:53]
    v_mul_f32 v26, v26, v60
    v_mul_f32 v27, v27, v61
    v_mfma_f32_16x16x32_bf16 v[36:39], v[110:113], v[40:43], 0
    v_max3_f32 v106, v20, v21, v22
    v_mul_f32 v16, v16, v62
    v_mfma_f32_16x16x32_bf16 v[36:39], v[126:129], v[86:89], v[36:39]
    v_cvt_pk_bf16_f32 v50, v50, v51
    v_cvt_pk_bf16_f32 v51, v52, v53
    v_mfma_f32_16x16x32_bf16 v[36:39], v[252:255], v[32:35], v[36:39]
    v_mul_f32 v17, v17, v63
    v_mul_f32 v18, v18, v64
    v_mfma_f32_16x16x32_bf16 v[102:105], v[118:121], v[40:43], 0
    v_mul_f32 v19, v19, v65
    v_max3_f32 v52, v23, v24, v25
    v_mfma_f32_16x16x32_bf16 v[102:105], v[134:137], v[86:89], v[102:105]
    v_cvt_pk_bf16_f32 v36, v36, v37
    v_cvt_pk_bf16_f32 v37, v38, v39
    v_mfma_f32_16x16x32_bf16 v[102:105], v[250:253], v[32:35], v[102:105]
    v_max3_f32 v106, v106, v26, v27
    v_mul_f32 v154, v154, v208
    v_mfma_f32_16x16x32_bf16 v[32:35], v[130:133], v[40:43], 0
    v_max3_f32 v52, v52, v16, v17
    v_max3_f32 v106, v106, v18, v19
    v_mfma_f32_16x16x32_bf16 v[32:35], v[138:141], v[86:89], v[32:35]
    buffer_store_dwordx4 v[48:51], v221, s[8:11], s27 offen offset:0 nt
    v_mfma_f32_16x16x32_bf16 v[32:35], v[252:255], v[28:31], v[32:35]
    v_cvt_pk_bf16_f32 v38, v102, v103
    v_cvt_pk_bf16_f32 v39, v104, v105
    v_mfma_f32_16x16x32_bf16 v[48:51], v[146:149], v[40:43], 0
    v_max3_f32 v106, v106, v52, v154
    v_mov_b32 v52, v106
    v_mfma_f32_16x16x32_bf16 v[48:51], v[142:145], v[86:89], v[48:51]
    v_cvt_pk_bf16_f32 v32, v32, v33
    v_cvt_pk_bf16_f32 v33, v34, v35
    v_mfma_f32_16x16x32_bf16 v[48:51], v[250:253], v[28:31], v[48:51]
    v_permlane32_swap_b32 v106, v52
    v_mfma_f32_16x16x32_bf16 v[28:31], a[168:171], v[74:77], 0
    v_max_f32 v106, v106, v52
    v_mov_b32 v52, v106
    v_mfma_f32_16x16x32_bf16 v[28:31], a[172:175], v[70:73], v[28:31]
    v_cvt_pk_bf16_f32 v34, v48, v49
    v_cvt_pk_bf16_f32 v35, v50, v51
    v_mfma_f32_16x16x32_bf16 v[28:31], a[176:179], v[66:69], v[28:31]
    v_permlane16_swap_b32 v106, v52
    v_mfma_f32_16x16x32_bf16 v[40:43], a[180:183], v[74:77], 0
    v_max_f32 v106, v106, v52
    v_mul_f32_e64 v173, -v106, v172
    v_mfma_f32_16x16x32_bf16 v[40:43], a[184:187], v[70:73], v[40:43]
    v_cvt_pk_bf16_f32 v28, v28, v29
    v_cvt_pk_bf16_f32 v29, v30, v31
    v_mfma_f32_16x16x32_bf16 v[40:43], a[188:191], v[66:69], v[40:43]
    v_fma_f32 v20, v20, v172, v173
    v_fma_f32 v21, v21, v172, v173
    v_mfma_f32_16x16x32_bf16 v[48:51], a[192:195], v[74:77], 0
    v_fma_f32 v22, v22, v172, v173
    v_fma_f32 v23, v23, v172, v173
    v_mfma_f32_16x16x32_bf16 v[48:51], a[196:199], v[70:73], v[48:51]
    v_cvt_pk_bf16_f32 v30, v40, v41
    v_cvt_pk_bf16_f32 v31, v42, v43
    v_mfma_f32_16x16x32_bf16 v[48:51], a[200:203], v[66:69], v[48:51]
    v_fma_f32 v24, v24, v172, v173
    v_fma_f32 v25, v25, v172, v173
    v_mfma_f32_16x16x32_bf16 v[86:89], a[204:207], v[74:77], 0
    buffer_load_dwordx4 v212, s[4:7], s24 offen nt lds
    s_add_u32 m0, s50, 1024
    v_mfma_f32_16x16x32_bf16 v[86:89], a[208:211], v[70:73], v[86:89]
    v_cvt_pk_bf16_f32 v40, v48, v49
    v_cvt_pk_bf16_f32 v41, v50, v51
    v_mfma_f32_16x16x32_bf16 v[86:89], a[212:215], v[66:69], v[86:89]
    ds_read_b32 v162, v228 offset:64
    v_fma_f32 v26, v26, v172, v173
    v_mfma_f32_16x16x32_bf16 v[102:105], v[0:3], a[216:219], 0
    v_fma_f32 v27, v27, v172, v173
    v_fma_f32 v16, v16, v172, v173
    v_mfma_f32_16x16x32_bf16 v[102:105], v[8:11], a[220:223], v[102:105]
    v_cvt_pk_bf16_f32 v42, v86, v87
    v_cvt_pk_bf16_f32 v43, v88, v89
    v_mfma_f32_16x16x32_bf16 v[102:105], v[4:7], a[224:227], v[102:105]
    v_fma_f32 v17, v17, v172, v173
    v_fma_f32 v18, v18, v172, v173
    v_mfma_f32_16x16x32_bf16 v[48:51], v[74:77], a[216:219], 0
    v_fma_f32 v19, v19, v172, v173
    v_fma_f32 v154, v154, v172, v173
    v_mfma_f32_16x16x32_bf16 v[48:51], v[70:73], a[220:223], v[48:51]
    v_cvt_pk_bf16_f32 v102, v102, v103
    v_cvt_pk_bf16_f32 v103, v104, v105
    v_mfma_f32_16x16x32_bf16 v[48:51], v[66:69], a[224:227], v[48:51]
    v_exp_f32 v20, v20
    v_mfma_f32_16x16x32_bf16 v[86:89], v[98:101], a[216:219], 0
    v_exp_f32 v21, v21
    v_mfma_f32_16x16x32_bf16 v[86:89], v[94:97], a[220:223], v[86:89]
    buffer_load_dwordx4 v213, s[4:7], s24 offen nt lds
    s_add_u32 m0, s50, 2048
    v_mfma_f32_16x16x32_bf16 v[86:89], v[90:93], a[224:227], v[86:89]
    v_cvt_pk_bf16_f32 v104, v48, v49
    v_cvt_pk_bf16_f32 v105, v50, v51
    v_mfma_f32_16x16x32_bf16 v[174:177], v[0:3], v[44:47], 0
    v_exp_f32 v22, v22
    v_mfma_f32_16x16x32_bf16 v[174:177], v[8:11], v[28:31], v[174:177]
    v_cvt_pk_bf16_f32 v114, v86, v87
    v_cvt_pk_bf16_f32 v115, v88, v89
    v_mfma_f32_16x16x32_bf16 v[174:177], v[4:7], v[40:43], v[174:177]
    v_exp_f32 v23, v23
    v_mfma_f32_16x16x32_bf16 v[178:181], v[74:77], v[44:47], 0
    v_exp_f32 v24, v24
    v_mfma_f32_16x16x32_bf16 v[178:181], v[70:73], v[28:31], v[178:181]
    v_exp_f32 v25, v25
    v_mfma_f32_16x16x32_bf16 v[178:181], v[66:69], v[40:43], v[178:181]
    v_exp_f32 v26, v26
    v_mfma_f32_16x16x32_bf16 v[86:89], v[98:101], v[44:47], 0
    v_exp_f32 v27, v27
    v_mfma_f32_16x16x32_bf16 v[86:89], v[94:97], v[28:31], v[86:89]
    v_exp_f32 v16, v16
    v_mfma_f32_16x16x32_bf16 v[86:89], v[90:93], v[40:43], v[86:89]
    buffer_load_dwordx4 v214, s[4:7], s24 offen nt lds
    s_add_u32 m0, s50, 3072
    v_mfma_f32_16x16x32_bf16 v[48:51], v[12:15], v[44:47], 0
    v_exp_f32 v17, v17
    v_mfma_f32_16x16x32_bf16 v[48:51], v[78:81], v[28:31], v[48:51]
    ds_read_b128 v[28:31], v231 offset:9216
    v_mul_f32 v174, v174, v54
    v_mfma_f32_16x16x32_bf16 v[48:51], v[82:85], v[40:43], v[48:51]
    ds_read_b128 v[40:43], v231 offset:11264
    v_mul_f32 v175, v175, v55
    v_mfma_f32_16x16x32_bf16 v[44:47], v[0:3], a[228:231], 0
    v_exp_f32 v18, v18
    v_mfma_f32_16x16x32_bf16 v[44:47], v[8:11], a[232:235], v[44:47]
    v_exp_f32 v19, v19
    v_exp_f32 v154, v154
    v_mul_f32 v176, v176, v56
    v_pk_add_f32 v[124:125], v[20:21], v[22:23]
    v_pk_add_f32 v[50:51], v[24:25], v[26:27]
    v_pk_add_f32 v[124:125], v[124:125], v[16:17]
    v_pk_add_f32 v[50:51], v[50:51], v[18:19]
    v_pk_add_f32 v[124:125], v[124:125], v[50:51]
    v_pk_mul_f32 v[20:21], v[20:21], v[54:55]
    v_pk_mul_f32 v[22:23], v[22:23], v[56:57]
    v_pk_mul_f32 v[24:25], v[24:25], v[58:59]
    v_pk_mul_f32 v[26:27], v[26:27], v[60:61]
    v_pk_mul_f32 v[16:17], v[16:17], v[62:63]
    v_pk_mul_f32 v[18:19], v[18:19], v[64:65]
    v_mfma_f32_16x16x32_bf16 v[44:47], v[4:7], a[236:239], v[44:47]
    v_add_f32 v124, v124, v125
    v_mov_b32 v125, v124
    v_mfma_f32_16x16x32_bf16 v[50:53], v[74:77], a[228:231], 0
    buffer_store_dwordx4 v[36:39], v221, s[8:11], s27 offen offset:64 nt
    v_mfma_f32_16x16x32_bf16 v[50:53], v[70:73], a[232:235], v[50:53]
    v_cvt_pk_bf16_f32 v106, v44, v45
    v_cvt_pk_bf16_f32 v107, v46, v47
    v_mfma_f32_16x16x32_bf16 v[50:53], v[66:69], a[236:239], v[50:53]
    v_permlane32_swap_b32 v124, v125
    v_mfma_f32_16x16x32_bf16 v[36:39], v[98:101], a[228:231], 0
    ds_read_b128 v[136:139], v231 offset:12288
    v_add_f32 v124, v124, v125
    v_mfma_f32_16x16x32_bf16 v[36:39], v[94:97], a[232:235], v[36:39]
    ds_read_b128 v[140:143], v231 offset:14336
    v_cvt_pk_bf16_f32 v108, v50, v51
    v_mfma_f32_16x16x32_bf16 v[36:39], v[90:93], a[236:239], v[36:39]
    ds_read_b128 v[144:147], v231 offset:16384
    v_cvt_pk_bf16_f32 v109, v52, v53
    v_mfma_f32_16x16x32_bf16 v[44:47], v[0:3], a[240:243], 0
    v_mov_b32 v125, v124
    v_mul_f32 v177, v177, v57
    v_mfma_f32_16x16x32_bf16 v[44:47], v[8:11], a[244:247], v[44:47]
    v_cvt_pk_bf16_f32 v122, v36, v37
    v_cvt_pk_bf16_f32 v123, v38, v39
    v_mfma_f32_16x16x32_bf16 v[44:47], v[4:7], a[248:251], v[44:47]
    v_permlane16_swap_b32 v124, v125
    v_mfma_f32_16x16x32_bf16 v[116:119], v[74:77], a[240:243], 0
    v_add_f32 v124, v124, v125
    v_add_f32 v124, v124, v154
    v_mfma_f32_16x16x32_bf16 v[116:119], v[70:73], a[244:247], v[116:119]
    v_cvt_pk_bf16_f32 v110, v44, v45
    v_cvt_pk_bf16_f32 v111, v46, v47
    v_mfma_f32_16x16x32_bf16 v[116:119], v[66:69], a[248:251], v[116:119]
    v_rcp_f32 v124, v124
    v_mfma_f32_16x16x32_bf16 v[126:129], v[98:101], a[240:243], 0
    ds_read_b128 v[36:39], v231 offset:13312
    v_mul_f32 v20, v20, v124
    v_mfma_f32_16x16x32_bf16 v[126:129], v[94:97], a[244:247], v[126:129]
    ds_read_b128 v[44:47], v231 offset:15360
    v_cvt_pk_bf16_f32 v112, v116, v117
    v_mfma_f32_16x16x32_bf16 v[126:129], v[90:93], a[248:251], v[126:129]
    buffer_load_dwordx4 v215, s[4:7], s24 offen nt lds
    ds_read_b128 v[50:53], v231 offset:17408
    v_mfma_f32_16x16x32_bf16 v[130:133], v[0:3], a[252:255], 0
    s_add_u32 m0, s50, 4096
    v_cvt_pk_bf16_f32 v113, v118, v119
    v_mul_f32 v21, v21, v124
    s_waitcnt lgkmcnt(7)
    v_mfma_f32_16x16x32_bf16 v[130:133], v[8:11], v[28:31], v[130:133]
    s_waitcnt lgkmcnt(6)
    v_cvt_pk_bf16_f32 v126, v126, v127
    v_cvt_pk_bf16_f32 v127, v128, v129
    v_mfma_f32_16x16x32_bf16 v[130:133], v[4:7], v[40:43], v[130:133]
    v_mul_f32 v22, v22, v124
    v_mul_f32 v23, v23, v124
    v_mfma_f32_16x16x32_bf16 v[148:151], v[74:77], a[252:255], 0
    v_mul_f32 v24, v24, v124
    v_mul_f32 v25, v25, v124
    v_mfma_f32_16x16x32_bf16 v[148:151], v[70:73], v[28:31], v[148:151]
    v_cvt_pk_bf16_f32 v118, v130, v131
    v_cvt_pk_bf16_f32 v119, v132, v133
    v_mfma_f32_16x16x32_bf16 v[148:151], v[66:69], v[40:43], v[148:151]
    v_mul_f32 v26, v26, v124
    v_mul_f32 v27, v27, v124
    v_mfma_f32_16x16x32_bf16 v[128:131], v[98:101], a[252:255], 0
    v_cvt_pk_bf16_f32 v20, v20, v21
    v_cvt_pk_bf16_f32 v21, v22, v23
    v_mfma_f32_16x16x32_bf16 v[128:131], v[94:97], v[28:31], v[128:131]
    v_cvt_pk_bf16_f32 v120, v148, v149
    v_cvt_pk_bf16_f32 v121, v150, v151
    v_mfma_f32_16x16x32_bf16 v[128:131], v[90:93], v[40:43], v[128:131]
    s_waitcnt lgkmcnt(5)
    v_cvt_pk_bf16_f32 v22, v24, v25
    v_cvt_pk_bf16_f32 v23, v26, v27
    v_mfma_f32_16x16x32_bf16 v[24:27], v[0:3], v[136:139], 0
    s_waitcnt lgkmcnt(4)
    buffer_load_dwordx4 v216, s[4:7], s24 offen nt lds
    s_add_u32 m0, s50, 5120
    v_mfma_f32_16x16x32_bf16 v[24:27], v[8:11], v[140:143], v[24:27]
    s_waitcnt lgkmcnt(3)
    v_cvt_pk_bf16_f32 v134, v128, v129
    v_cvt_pk_bf16_f32 v135, v130, v131
    v_mfma_f32_16x16x32_bf16 v[24:27], v[4:7], v[144:147], v[24:27]
    v_mul_f32 v154, v154, v208
    v_mul_f32 v154, v154, v124
    v_mfma_f32_16x16x32_bf16 v[28:31], v[74:77], v[136:139], 0
    v_mul_f32 v16, v16, v124
    v_mul_f32 v17, v17, v124
    v_mfma_f32_16x16x32_bf16 v[28:31], v[70:73], v[140:143], v[28:31]
    v_cvt_pk_bf16_f32 v130, v24, v25
    v_cvt_pk_bf16_f32 v131, v26, v27
    v_mfma_f32_16x16x32_bf16 v[28:31], v[66:69], v[144:147], v[28:31]
    v_mul_f32 v18, v18, v124
    v_mul_f32 v19, v19, v124
    v_mfma_f32_16x16x32_bf16 v[24:27], v[98:101], v[136:139], 0
    v_cvt_pk_bf16_f32 v154, v154, v154
    v_cvt_pk_bf16_f32 v16, v16, v17
    v_mfma_f32_16x16x32_bf16 v[24:27], v[94:97], v[140:143], v[24:27]
    v_cvt_pk_bf16_f32 v132, v28, v29
    v_cvt_pk_bf16_f32 v133, v30, v31
    v_mfma_f32_16x16x32_bf16 v[24:27], v[90:93], v[144:147], v[24:27]
    ds_read_b64 v[116:117], v223
    ds_read_b64 v[124:125], v223 offset:32
    s_waitcnt lgkmcnt(4)
    v_mfma_f32_16x16x32_bf16 v[28:31], v[0:3], v[36:39], 0
    ds_read_b64 v[128:129], v223 offset:64
    ds_read_b64 v[136:137], v223 offset:96
    s_waitcnt lgkmcnt(5)
    v_mfma_f32_16x16x32_bf16 v[28:31], v[8:11], v[44:47], v[28:31]
    ds_read_b64 v[140:141], v223 offset:128
    ds_read_b64 v[144:145], v223 offset:160
    s_waitcnt lgkmcnt(6)
    v_mfma_f32_16x16x32_bf16 v[28:31], v[4:7], v[50:53], v[28:31]
    buffer_load_dwordx4 v217, s[4:7], s24 offen nt lds
    v_cvt_pk_bf16_f32 v138, v24, v25
    v_mfma_f32_16x16x32_bf16 v[40:43], v[74:77], v[36:39], 0
    s_add_u32 m0, s50, 6144
    v_cvt_pk_bf16_f32 v139, v26, v27
    v_cvt_pk_bf16_f32 v17, v18, v19
    v_mfma_f32_16x16x32_bf16 v[40:43], v[70:73], v[44:47], v[40:43]
    v_cvt_pk_bf16_f32 v146, v28, v29
    v_cvt_pk_bf16_f32 v147, v30, v31
    v_mfma_f32_16x16x32_bf16 v[40:43], v[66:69], v[50:53], v[40:43]
    v_and_b32 v18, v154, v236
    v_and_b32 v19, v154, v237
    v_mfma_f32_16x16x32_bf16 v[24:27], v[98:101], v[36:39], 0
    v_mul_f32 v178, v178, v58
    v_mul_f32 v179, v179, v59
    v_mfma_f32_16x16x32_bf16 v[24:27], v[94:97], v[44:47], v[24:27]
    v_cvt_pk_bf16_f32 v148, v40, v41
    v_cvt_pk_bf16_f32 v149, v42, v43
    v_mfma_f32_16x16x32_bf16 v[24:27], v[90:93], v[50:53], v[24:27]
    v_mul_f32 v180, v180, v60
    v_mul_f32 v181, v181, v61
    v_mfma_f32_16x16x32_bf16 v[36:39], a[144:147], v[98:101], 0
    v_max3_f32 v44, v174, v175, v176
    v_mul_f32 v86, v86, v62
    v_mfma_f32_16x16x32_bf16 v[36:39], a[148:151], v[94:97], v[36:39]
    v_cvt_pk_bf16_f32 v142, v24, v25
    v_cvt_pk_bf16_f32 v143, v26, v27
    v_mfma_f32_16x16x32_bf16 v[36:39], a[152:155], v[90:93], v[36:39]
    v_mul_f32 v87, v87, v63
    v_mul_f32_e64 v88, v88, v64
    v_mfma_f32_16x16x32_bf16 v[26:29], a[156:159], v[98:101], 0
    buffer_store_dwordx4 v[32:35], v221, s[8:11], s27 offen offset:128 nt
    v_mfma_f32_16x16x32_bf16 v[26:29], a[160:163], v[94:97], v[26:29]
    s_mov_b32 s10, 109734912
    v_cvt_pk_bf16_f32 v24, v36, v37
    v_cvt_pk_bf16_f32 v25, v38, v39
    v_mfma_f32_16x16x32_bf16 v[26:29], a[164:167], v[90:93], v[26:29]
    s_mov_b32 s27, s26
    v_mul_f32 v89, v89, v65
    v_max3_f32 v45, v177, v178, v179
    v_mfma_f32_16x16x32_bf16 v[30:33], a[168:171], v[98:101], 0
    v_max3_f32 v44, v44, v180, v181
    v_mul_f32 v48, v48, v208
    v_mfma_f32_16x16x32_bf16 v[30:33], a[172:175], v[94:97], v[30:33]
    v_cvt_pk_bf16_f32 v26, v26, v27
    v_cvt_pk_bf16_f32 v27, v28, v29
    v_mfma_f32_16x16x32_bf16 v[30:33], a[176:179], v[90:93], v[30:33]
    ds_read_b32 v206, v228 offset:128
    v_max3_f32 v45, v45, v86, v87
    v_mfma_f32_16x16x32_bf16 v[34:37], a[180:183], v[98:101], 0
    v_max3_f32 v44, v44, v88, v89
    v_max3_f32 v44, v44, v45, v48
    v_mfma_f32_16x16x32_bf16 v[34:37], a[184:187], v[94:97], v[34:37]
    v_cvt_pk_bf16_f32 v28, v30, v31
    v_cvt_pk_bf16_f32 v29, v32, v33
    v_mfma_f32_16x16x32_bf16 v[34:37], a[188:191], v[90:93], v[34:37]
    v_mov_b32 v45, v44
    v_add_u32 v230, s42, v230
    v_mfma_f32_16x16x32_bf16 v[38:41], a[192:195], v[98:101], 0
    s_mov_b32 s42, s58
    v_permlane32_swap_b32 v44, v45
    v_mfma_f32_16x16x32_bf16 v[38:41], a[196:199], v[94:97], v[38:41]
    v_cvt_pk_bf16_f32 v30, v34, v35
    v_cvt_pk_bf16_f32 v31, v36, v37
    v_mfma_f32_16x16x32_bf16 v[38:41], a[200:203], v[90:93], v[38:41]
    v_max_f32 v44, v44, v45
    v_mov_b32 v45, v44
    v_mfma_f32_16x16x32_bf16 v[34:37], a[204:207], v[98:101], 0
    v_add_u32 v209, s58, v226
    v_mfma_f32_16x16x32_bf16 v[34:37], a[208:211], v[94:97], v[34:37]
    v_cvt_pk_bf16_f32 v32, v38, v39
    v_cvt_pk_bf16_f32 v33, v40, v41
    v_mfma_f32_16x16x32_bf16 v[34:37], a[212:215], v[90:93], v[34:37]
    buffer_load_dwordx4 v218, s[4:7], s24 offen nt lds
    s_add_u32 m0, s50, 7168
    v_mfma_f32_16x16x32_bf16 v[40:43], v[102:105], v[20:23], 0
    s_waitcnt lgkmcnt(6)
    v_permlane16_swap_b32 v44, v45
    v_mfma_f32_16x16x32_bf16 v[40:43], v[114:117], v[16:19], v[40:43]
    v_cvt_pk_bf16_f32 v34, v34, v35
    v_cvt_pk_bf16_f32 v35, v36, v37
    v_mfma_f32_16x16x32_bf16 v[40:43], v[252:255], v[0:3], v[40:43]
    v_max_f32 v44, v44, v45
    v_mul_f32_e64 v163, -v44, v162
    v_mfma_f32_16x16x32_bf16 v[36:39], v[106:109], v[20:23], 0
    s_waitcnt lgkmcnt(5)
    v_fma_f32 v174, v174, v162, v163
    v_fma_f32 v175, v175, v162, v163
    v_mfma_f32_16x16x32_bf16 v[36:39], v[122:125], v[16:19], v[36:39]
    v_cvt_pk_bf16_f32 v40, v40, v41
    v_cvt_pk_bf16_f32 v41, v42, v43
    v_mfma_f32_16x16x32_bf16 v[36:39], v[250:253], v[0:3], v[36:39]
    v_fma_f32 v176, v176, v162, v163
    v_fma_f32 v177, v177, v162, v163
    v_mfma_f32_16x16x32_bf16 v[150:153], v[110:113], v[20:23], 0
    s_waitcnt lgkmcnt(4)
    v_fma_f32 v178, v178, v162, v163
    v_fma_f32 v179, v179, v162, v163
    v_mfma_f32_16x16x32_bf16 v[150:153], v[126:129], v[16:19], v[150:153]
    v_cvt_pk_bf16_f32 v42, v36, v37
    v_cvt_pk_bf16_f32 v43, v38, v39
    v_mfma_f32_16x16x32_bf16 v[150:153], v[252:255], v[8:11], v[150:153]
    ds_write_b128 v226, v[40:43]
    v_mfma_f32_16x16x32_bf16 v[158:161], v[118:121], v[20:23], 0
    s_waitcnt lgkmcnt(4)
    buffer_load_dwordx4 v219, s[4:7], s24 offen nt lds
    s_add_u32 m0, s50, 8192
    v_mfma_f32_16x16x32_bf16 v[158:161], v[134:137], v[16:19], v[158:161]
    v_fma_f32 v180, v180, v162, v163
    v_fma_f32 v181, v181, v162, v163
    v_mfma_f32_16x16x32_bf16 v[158:161], v[250:253], v[8:11], v[158:161]
    v_fma_f32 v86, v86, v162, v163
    v_fma_f32 v87, v87, v162, v163
    v_mfma_f32_16x16x32_bf16 v[154:157], v[130:133], v[20:23], 0
    s_waitcnt lgkmcnt(3)
    v_fma_f32 v88, v88, v162, v163
    v_fma_f32 v89, v89, v162, v163
    v_mfma_f32_16x16x32_bf16 v[154:157], v[138:141], v[16:19], v[154:157]
    v_exp_f32 v174, v174
    v_mfma_f32_16x16x32_bf16 v[154:157], v[252:255], v[4:7], v[154:157]
    v_exp_f32 v175, v175
    v_mfma_f32_16x16x32_bf16 v[182:185], v[146:149], v[20:23], 0
    s_waitcnt lgkmcnt(2)
    v_exp_f32 v176, v176
    v_mfma_f32_16x16x32_bf16 v[182:185], v[142:145], v[16:19], v[182:185]
    v_exp_f32 v177, v177
    v_mfma_f32_16x16x32_bf16 v[182:185], v[250:253], v[4:7], v[182:185]
    v_exp_f32 v178, v178
    v_mfma_f32_16x16x32_bf16 v[166:169], v[0:3], v[24:27], 0
    v_exp_f32 v179, v179
    v_mfma_f32_16x16x32_bf16 v[166:169], v[8:11], v[28:31], v[166:169]
    v_exp_f32 v180, v180
    v_mfma_f32_16x16x32_bf16 v[166:169], v[4:7], v[32:35], v[166:169]
    ds_read_b128 v[16:19], v222 offset:768
    ds_read_b128 v[190:193], v222 offset:832
    v_mfma_f32_16x16x32_bf16 v[170:173], v[74:77], v[24:27], 0
    ds_read_b128 v[194:197], v222 offset:896
    buffer_load_dwordx4 v220, s[4:7], s24 offen nt lds
    v_mfma_f32_16x16x32_bf16 v[170:173], v[70:73], v[28:31], v[170:173]
    ds_read_b128 v[38:41], v232
    v_fma_f32 v48, v48, v162, v163
    v_mfma_f32_16x16x32_bf16 v[170:173], v[66:69], v[32:35], v[170:173]
    ds_read_b128 v[44:47], v232 offset:64
    v_cvt_pk_bf16_f32 v198, v150, v151
    v_mfma_f32_16x16x32_bf16 v[162:165], v[98:101], v[24:27], 0
    ds_read_b128 v[50:53], v232 offset:128
    v_cvt_pk_bf16_f32 v199, v152, v153
    v_mfma_f32_16x16x32_bf16 v[162:165], v[94:97], v[28:31], v[162:165]
    v_exp_f32 v181, v181
    v_mfma_f32_16x16x32_bf16 v[162:165], v[90:93], v[32:35], v[162:165]
    v_exp_f32 v86, v86
    v_mfma_f32_16x16x32_bf16 v[186:189], v[12:15], v[24:27], 0
    v_exp_f32 v87, v87
    v_mfma_f32_16x16x32_bf16 v[186:189], v[78:81], v[28:31], v[186:189]
    v_exp_f32 v88, v88
    v_mfma_f32_16x16x32_bf16 v[186:189], v[82:85], v[32:35], v[186:189]
    s_waitcnt lgkmcnt(5)
    v_exp_f32 v89, v89
    v_exp_f32 v48, v48
    v_cvt_pk_bf16_f32 v200, v158, v159
    v_pk_add_f32 v[24:25], v[174:175], v[176:177]
    v_pk_add_f32 v[20:21], v[178:179], v[180:181]
    v_pk_add_f32 v[24:25], v[24:25], v[86:87]
    v_pk_add_f32 v[20:21], v[20:21], v[88:89]
    v_pk_add_f32 v[24:25], v[24:25], v[20:21]
    v_pk_mul_f32 v[174:175], v[174:175], v[54:55]
    v_pk_mul_f32 v[176:177], v[176:177], v[56:57]
    v_pk_mul_f32 v[178:179], v[178:179], v[58:59]
    v_pk_mul_f32 v[180:181], v[180:181], v[60:61]
    v_pk_mul_f32 v[86:87], v[86:87], v[62:63]
    v_pk_mul_f32 v[88:89], v[88:89], v[64:65]
    v_mfma_f32_16x16x32_bf16 v[150:153], v[0:3], v[16:19], 0
    s_waitcnt lgkmcnt(4)
    v_add_f32 v24, v24, v25
    v_mov_b32 v25, v24
    v_mfma_f32_16x16x32_bf16 v[150:153], v[8:11], v[190:193], v[150:153]
    s_waitcnt lgkmcnt(3)
    v_cvt_pk_bf16_f32 v201, v160, v161
    v_cvt_pk_bf16_f32 v202, v154, v155
    v_mfma_f32_16x16x32_bf16 v[150:153], v[4:7], v[194:197], v[150:153]
    ds_read_b128 v[20:23], v233
    ds_read_b128 v[26:29], v233 offset:64
    v_mfma_f32_16x16x32_bf16 v[158:161], v[74:77], v[16:19], 0
    ds_read_b128 v[32:35], v233 offset:128
    v_cvt_pk_bf16_f32 v203, v156, v157
    v_mfma_f32_16x16x32_bf16 v[158:161], v[70:73], v[190:193], v[158:161]
    ds_write_b128 v226, v[198:201] offset:64
    v_mfma_f32_16x16x32_bf16 v[158:161], v[66:69], v[194:197], v[158:161]
    v_permlane32_swap_b32 v24, v25
    v_mfma_f32_16x16x32_bf16 v[154:157], v[98:101], v[16:19], 0
    v_add_f32 v24, v24, v25
    v_mov_b32 v25, v24
    v_mfma_f32_16x16x32_bf16 v[154:157], v[94:97], v[190:193], v[154:157]
    v_cvt_pk_bf16_f32 v204, v182, v183
    v_cvt_pk_bf16_f32 v205, v184, v185
    v_mfma_f32_16x16x32_bf16 v[154:157], v[90:93], v[194:197], v[154:157]
    ds_read_b128 v[2:5], v234
    ds_read_b128 v[8:11], v234 offset:64
    v_mfma_f32_16x16x32_bf16 v[182:185], v[12:15], v[16:19], 0
    ds_read_b128 v[14:17], v234 offset:128
    v_mul_f32 v166, v166, v54
    v_mfma_f32_16x16x32_bf16 v[182:185], v[78:81], v[190:193], v[182:185]
    ds_write_b128 v226, v[202:205] offset:128
    v_mfma_f32_16x16x32_bf16 v[182:185], v[82:85], v[194:197], v[182:185]
    s_waitcnt lgkmcnt(10)
    v_permlane16_swap_b32 v24, v25
    v_mfma_f32_16x16x32_bf16 v[188:191], v[38:41], v[38:41], 0
    s_waitcnt lgkmcnt(9)
    v_add_f32 v24, v24, v25
    v_add_f32 v24, v24, v48
    v_mfma_f32_16x16x32_bf16 v[188:191], v[44:47], v[44:47], v[188:191]
    ds_read_b128 v[82:85], v230
    v_mul_f32 v48, v48, v208
    s_waitcnt lgkmcnt(9)
    v_mfma_f32_16x16x32_bf16 v[188:191], v[50:53], v[50:53], v[188:191]
    v_rcp_f32 v24, v24
    v_mfma_f32_16x16x32_bf16 v[192:195], v[238:241], v[38:41], 0
    v_mul_f32 v174, v174, v24
    v_mul_f32 v175, v175, v24
    v_mfma_f32_16x16x32_bf16 v[192:195], v[242:245], v[44:47], v[192:195]
    v_mul_f32 v176, v176, v24
    v_mul_f32 v177, v177, v24
    v_mfma_f32_16x16x32_bf16 v[192:195], v[246:249], v[50:53], v[192:195]
    s_waitcnt lgkmcnt(8)
    v_mul_f32 v178, v178, v24
    v_mul_f32 v179, v179, v24
    v_mfma_f32_16x16x32_bf16 v[196:199], v[20:23], v[20:23], 0
    s_waitcnt lgkmcnt(7)
    v_mul_f32 v180, v180, v24
    v_mul_f32 v181, v181, v24
    v_mfma_f32_16x16x32_bf16 v[196:199], v[26:29], v[26:29], v[196:199]
    s_waitcnt lgkmcnt(6)
    v_cvt_pk_bf16_f32 v78, v174, v175
    v_cvt_pk_bf16_f32 v79, v176, v177
    v_mfma_f32_16x16x32_bf16 v[196:199], v[32:35], v[32:35], v[196:199]
    v_cvt_pk_bf16_f32 v80, v178, v179
    v_cvt_pk_bf16_f32 v81, v180, v181
    v_mfma_f32_16x16x32_bf16 v[178:181], v[238:241], v[20:23], 0
    v_mul_f32 v48, v48, v24
    v_mul_f32 v86, v86, v24
    v_mfma_f32_16x16x32_bf16 v[178:181], v[242:245], v[26:29], v[178:181]
    s_waitcnt lgkmcnt(0)
    buffer_store_dwordx4 v[82:85], v212, s[8:11], s26 offen nt
    v_mfma_f32_16x16x32_bf16 v[178:181], v[246:249], v[32:35], v[178:181]
    ds_read_b128 v[174:177], v230 offset:1024
    v_mul_f32 v87, v87, v24
    v_mfma_f32_16x16x32_bf16 v[200:203], v[2:5], v[2:5], 0
    v_mul_f32 v88, v88, v24
    v_mul_f32 v89, v89, v24
    v_mfma_f32_16x16x32_bf16 v[200:203], v[8:11], v[8:11], v[200:203]
    v_cvt_pk_bf16_f32 v48, v48, v48
    v_cvt_pk_bf16_f32 v82, v86, v87
    v_mfma_f32_16x16x32_bf16 v[200:203], v[14:17], v[14:17], v[200:203]
    v_cvt_pk_bf16_f32 v83, v88, v89
    v_and_b32 v84, v48, v236
    v_mfma_f32_16x16x32_bf16 v[86:89], v[238:241], v[2:5], 0
    v_and_b32 v85, v48, v237
    v_cndmask_b32_e64 v0, v196, v197, s[32:33]
    v_mfma_f32_16x16x32_bf16 v[86:89], v[242:245], v[8:11], v[86:89]
    v_cndmask_b32_e64 v0, v0, v198, s[34:35]
    v_cndmask_b32_e64 v6, v188, v189, s[32:33]
    v_mfma_f32_16x16x32_bf16 v[86:89], v[246:249], v[14:17], v[86:89]
    v_cndmask_b32_e64 v0, v0, v199, s[36:37]
    v_cndmask_b32_e64 v6, v6, v190, s[34:35]
    v_mfma_f32_16x16x32_bf16 v[194:197], v[102:105], v[78:81], 0
    v_cndmask_b32_e64 v1, v200, v201, s[32:33]
    v_cndmask_b32_e64 v6, v6, v191, s[36:37]
    v_mfma_f32_16x16x32_bf16 v[194:197], v[114:117], v[82:85], v[194:197]
    v_cndmask_b32_e64 v1, v1, v202, s[34:35]
    v_cndmask_b32_e64 v1, v1, v203, s[36:37]
    v_mfma_f32_16x16x32_bf16 v[194:197], v[252:255], v[74:77], v[194:197]
    v_cndmask_b32_dpp v0, v0, v6, vcc row_ror:4 row_mask:0xf bank_mask:0xf
    v_cndmask_b32_dpp v183, v178, v192, vcc row_ror:4 row_mask:0xf bank_mask:0xf
    v_mfma_f32_16x16x32_bf16 v[188:191], v[106:109], v[78:81], 0
    v_cndmask_b32_dpp v187, v179, v193, vcc row_ror:4 row_mask:0xf bank_mask:0xf
    s_mov_b64 vcc, s[40:41]
    v_mfma_f32_16x16x32_bf16 v[188:191], v[122:125], v[82:85], v[188:191]
    v_cvt_pk_bf16_f32 v192, v194, v195
    v_cvt_pk_bf16_f32 v193, v196, v197
    v_mfma_f32_16x16x32_bf16 v[188:191], v[250:253], v[74:77], v[188:191]
    v_cndmask_b32_dpp v183, v86, v183, vcc row_ror:8 row_mask:0xf bank_mask:0xf
    v_cndmask_b32_dpp v0, v1, v0, vcc row_ror:8 row_mask:0xf bank_mask:0xf
    v_mfma_f32_16x16x32_bf16 v[178:181], v[110:113], v[78:81], 0
    s_waitcnt lgkmcnt(0)
    buffer_store_dwordx4 v[174:177], v213, s[8:11], s26 offen nt
    v_mfma_f32_16x16x32_bf16 v[178:181], v[126:129], v[82:85], v[178:181]
    ds_read_b128 v[74:77], v230 offset:2048
    v_cvt_pk_bf16_f32 v194, v188, v189
    v_mfma_f32_16x16x32_bf16 v[178:181], v[252:255], v[70:73], v[178:181]
    v_cvt_pk_bf16_f32 v195, v190, v191
    v_mul_f32 v1, v183, v183
    v_mfma_f32_16x16x32_bf16 v[174:177], v[118:121], v[78:81], 0
    ds_write_b128 v226, v[192:195] offset:3072
    v_mfma_f32_16x16x32_bf16 v[174:177], v[134:137], v[82:85], v[174:177]
    v_cvt_pk_bf16_f32 v178, v178, v179
    v_cvt_pk_bf16_f32 v179, v180, v181
    v_mfma_f32_16x16x32_bf16 v[174:177], v[250:253], v[70:73], v[174:177]
    v_fmamk_f32 v1, v1, 0xbc2aaaab, v0
    v_cndmask_b32_dpp v187, v87, v187, vcc row_ror:8 row_mask:0xf bank_mask:0xf
    v_mfma_f32_16x16x32_bf16 v[86:89], v[130:133], v[78:81], 0
    s_mov_b64 vcc, s[38:39]
    v_add_f32_e64 v1, |v1|, s51
    v_mul_f32 v167, v167, v55
    v_mfma_f32_16x16x32_bf16 v[86:89], v[138:141], v[82:85], v[86:89]
    v_cvt_pk_bf16_f32 v180, v174, v175
    v_cvt_pk_bf16_f32 v181, v176, v177
    v_mfma_f32_16x16x32_bf16 v[86:89], v[252:255], v[66:69], v[86:89]
    ds_write_b128 v226, v[178:181] offset:3136
    v_mfma_f32_16x16x32_bf16 v[70:73], v[146:149], v[78:81], 0
    v_cvt_pk_bf16_f32 v80, v86, v87
    v_cvt_pk_bf16_f32 v81, v88, v89
    v_mfma_f32_16x16x32_bf16 v[70:73], v[142:145], v[82:85], v[70:73]
    v_rsq_f32 v6, v1
    v_mfma_f32_16x16x32_bf16 v[70:73], v[250:253], v[66:69], v[70:73]
    v_mul_f32 v168, v168, v56
    v_mul_f32 v169, v169, v57
    v_mfma_f32_16x16x32_bf16 v[66:69], a[72:75], v[38:41], 0
    v_mul_f32 v170, v170, v58
    v_mul_f32 v171, v171, v59
    v_mfma_f32_16x16x32_bf16 v[66:69], a[76:79], v[44:47], v[66:69]
    s_waitcnt lgkmcnt(2)
    buffer_store_dwordx4 v[74:77], v214, s[8:11], s26 offen nt
    v_mfma_f32_16x16x32_bf16 v[66:69], a[80:83], v[50:53], v[66:69]
    v_cvt_pk_bf16_f32 v82, v70, v71
    v_cvt_pk_bf16_f32 v83, v72, v73
    v_mfma_f32_16x16x32_bf16 v[76:79], a[84:87], v[38:41], 0
    ds_write_b128 v226, v[80:83] offset:3200
    v_mfma_f32_16x16x32_bf16 v[76:79], a[88:91], v[44:47], v[76:79]
    v_cvt_pk_bf16_f32 v74, v66, v67
    v_cvt_pk_bf16_f32 v75, v68, v69
    v_mfma_f32_16x16x32_bf16 v[76:79], a[92:95], v[50:53], v[76:79]
    ds_read_b128 v[66:69], v230 offset:3072
    v_mul_f32 v172, v172, v60
    v_mfma_f32_16x16x32_bf16 v[70:73], a[96:99], v[38:41], 0
    v_mul_f32 v173, v173, v61
    v_max3_f32 v0, v166, v167, v168
    v_mfma_f32_16x16x32_bf16 v[70:73], a[100:103], v[44:47], v[70:73]
    v_cvt_pk_bf16_f32 v76, v76, v77
    v_cvt_pk_bf16_f32 v77, v78, v79
    v_mfma_f32_16x16x32_bf16 v[70:73], a[104:107], v[50:53], v[70:73]
    v_mul_f32 v162, v162, v62
    v_mul_f32 v163, v163, v63
    v_mfma_f32_16x16x32_bf16 v[78:81], a[108:111], v[38:41], 0
    v_mul_f32 v164, v164, v64
    v_mul_f32 v165, v165, v65
    v_mfma_f32_16x16x32_bf16 v[78:81], a[112:115], v[44:47], v[78:81]
    v_cvt_pk_bf16_f32 v82, v70, v71
    v_cvt_pk_bf16_f32 v83, v72, v73
    v_mfma_f32_16x16x32_bf16 v[78:81], a[116:119], v[50:53], v[78:81]
    v_max3_f32 v1, v169, v170, v171
    v_max3_f32 v0, v0, v172, v173
    v_mfma_f32_16x16x32_bf16 v[70:73], a[120:123], v[38:41], 0
    v_mul_f32 v186, v186, v208
    v_max3_f32 v1, v1, v162, v163
    v_mfma_f32_16x16x32_bf16 v[70:73], a[124:127], v[44:47], v[70:73]
    v_cvt_pk_bf16_f32 v84, v78, v79
    v_cvt_pk_bf16_f32 v85, v80, v81
    v_mfma_f32_16x16x32_bf16 v[70:73], a[128:131], v[50:53], v[70:73]
    v_max3_f32 v0, v0, v164, v165
    v_max3_f32 v0, v0, v1, v186
    v_mfma_f32_16x16x32_bf16 v[174:177], a[132:135], v[38:41], 0
    s_waitcnt lgkmcnt(0)
    buffer_store_dwordx4 v[66:69], v215, s[8:11], s26 offen nt
    v_mfma_f32_16x16x32_bf16 v[174:177], a[136:139], v[44:47], v[174:177]
    ds_read_b128 v[78:81], v230 offset:4096
    v_cvt_pk_bf16_f32 v86, v70, v71
    v_mfma_f32_16x16x32_bf16 v[174:177], a[140:143], v[50:53], v[174:177]
    v_cvt_pk_bf16_f32 v87, v72, v73
    v_mov_b32 v1, v0
    v_mfma_f32_16x16x32_bf16 v[66:69], a[72:75], v[20:23], 0
    v_mfma_f32_16x16x32_bf16 v[66:69], a[76:79], v[26:29], v[66:69]
    v_cvt_pk_bf16_f32 v88, v174, v175
    v_cvt_pk_bf16_f32 v89, v176, v177
    v_mfma_f32_16x16x32_bf16 v[66:69], a[80:83], v[32:35], v[66:69]
    v_permlane32_swap_b32 v0, v1
    v_mfma_f32_16x16x32_bf16 v[174:177], a[84:87], v[20:23], 0
    v_max_f32 v0, v0, v1
    v_mov_b32 v1, v0
    v_mfma_f32_16x16x32_bf16 v[174:177], a[88:91], v[26:29], v[174:177]
    v_cvt_pk_bf16_f32 v72, v66, v67
    v_cvt_pk_bf16_f32 v73, v68, v69
    v_mfma_f32_16x16x32_bf16 v[174:177], a[92:95], v[32:35], v[174:177]
    v_permlane16_swap_b32 v0, v1
    v_mfma_f32_16x16x32_bf16 v[66:69], v[38:41], v[74:77], 0
    v_max_f32 v0, v0, v1
    v_mul_f32_e64 v207, -v0, v206
    v_mfma_f32_16x16x32_bf16 v[66:69], v[44:47], v[82:85], v[66:69]
    v_cvt_pk_bf16_f32 v74, v174, v175
    v_cvt_pk_bf16_f32 v75, v176, v177
    v_mfma_f32_16x16x32_bf16 v[66:69], v[50:53], v[86:89], v[66:69]
    v_fma_f32 v166, v166, v206, v207
    v_fma_f32 v167, v167, v206, v207
    v_mfma_f32_16x16x32_bf16 v[174:177], a[96:99], v[20:23], 0
    v_fma_f32 v168, v168, v206, v207
    v_fma_f32 v169, v169, v206, v207
    v_mfma_f32_16x16x32_bf16 v[174:177], a[100:103], v[26:29], v[174:177]
    v_fma_f32 v170, v170, v206, v207
    v_fma_f32 v171, v171, v206, v207
    v_mfma_f32_16x16x32_bf16 v[174:177], a[104:107], v[32:35], v[174:177]
    s_waitcnt lgkmcnt(0)
    buffer_store_dwordx4 v[78:81], v216, s[8:11], s26 offen nt
    v_mfma_f32_16x16x32_bf16 v[86:89], a[108:111], v[20:23], 0
    ds_read_b128 v[82:85], v230 offset:5120
    v_fma_f32 v172, v172, v206, v207
    v_mfma_f32_16x16x32_bf16 v[86:89], a[112:115], v[26:29], v[86:89]
    v_cvt_pk_bf16_f32 v76, v174, v175
    v_cvt_pk_bf16_f32 v77, v176, v177
    v_mfma_f32_16x16x32_bf16 v[86:89], a[116:119], v[32:35], v[86:89]
    v_fma_f32 v173, v173, v206, v207
    v_fma_f32 v162, v162, v206, v207
    v_mfma_f32_16x16x32_bf16 v[174:177], a[120:123], v[20:23], 0
    v_fma_f32 v163, v163, v206, v207
    v_fma_f32 v164, v164, v206, v207
    v_mfma_f32_16x16x32_bf16 v[174:177], a[124:127], v[26:29], v[174:177]
    v_cvt_pk_bf16_f32 v78, v86, v87
    v_cvt_pk_bf16_f32 v79, v88, v89
    v_mfma_f32_16x16x32_bf16 v[174:177], a[128:131], v[32:35], v[174:177]
    v_fma_f32 v165, v165, v206, v207
    v_fma_f32 v186, v186, v206, v207
    v_mfma_f32_16x16x32_bf16 v[178:181], a[132:135], v[20:23], 0
    v_exp_f32 v166, v166
    v_mfma_f32_16x16x32_bf16 v[178:181], a[136:139], v[26:29], v[178:181]
    v_cvt_pk_bf16_f32 v86, v174, v175
    v_cvt_pk_bf16_f32 v87, v176, v177
    v_mfma_f32_16x16x32_bf16 v[178:181], a[140:143], v[32:35], v[178:181]
    v_exp_f32 v167, v167
    v_mfma_f32_16x16x32_bf16 v[174:177], a[72:75], v[2:5], 0
    v_exp_f32 v168, v168
    v_mfma_f32_16x16x32_bf16 v[174:177], a[76:79], v[8:11], v[174:177]
    v_cvt_pk_bf16_f32 v88, v178, v179
    v_cvt_pk_bf16_f32 v89, v180, v181
    v_mfma_f32_16x16x32_bf16 v[174:177], a[80:83], v[14:17], v[174:177]
    v_exp_f32 v169, v169
    v_mfma_f32_16x16x32_bf16 v[178:181], a[84:87], v[2:5], 0
    v_exp_f32 v170, v170
    v_mfma_f32_16x16x32_bf16 v[178:181], a[88:91], v[8:11], v[178:181]
    s_waitcnt lgkmcnt(0)
    buffer_store_dwordx4 v[82:85], v217, s[8:11], s26 offen nt
    v_mfma_f32_16x16x32_bf16 v[178:181], a[92:95], v[14:17], v[178:181]
    s_mov_b32 s26, s25
    v_cvt_pk_bf16_f32 v70, v174, v175
    v_cvt_pk_bf16_f32 v71, v176, v177
    v_mfma_f32_16x16x32_bf16 v[80:83], v[20:23], v[72:75], 0
    s_mov_b32 s25, s24
    v_exp_f32 v171, v171
    v_mfma_f32_16x16x32_bf16 v[80:83], v[26:29], v[76:79], v[80:83]
    v_cvt_pk_bf16_f32 v72, v178, v179
    v_cvt_pk_bf16_f32 v73, v180, v181
    v_mfma_f32_16x16x32_bf16 v[80:83], v[32:35], v[86:89], v[80:83]
    v_exp_f32 v172, v172
    v_mfma_f32_16x16x32_bf16 v[74:77], a[96:99], v[2:5], 0
    v_exp_f32 v173, v173
    v_mfma_f32_16x16x32_bf16 v[74:77], a[100:103], v[8:11], v[74:77]
    v_cndmask_b32_dpp v13, v80, v66, vcc row_ror:4 row_mask:0xf bank_mask:0xf
    v_cndmask_b32_dpp v18, v81, v67, vcc row_ror:4 row_mask:0xf bank_mask:0xf
    v_mfma_f32_16x16x32_bf16 v[74:77], a[104:107], v[14:17], v[74:77]
    v_cndmask_b32_dpp v7, v82, v68, vcc row_ror:4 row_mask:0xf bank_mask:0xf
    v_cndmask_b32_dpp v12, v83, v69, vcc row_ror:4 row_mask:0xf bank_mask:0xf
    v_mfma_f32_16x16x32_bf16 v[78:81], a[108:111], v[2:5], 0
    s_mov_b64 vcc, s[40:41]
    v_exp_f32 v162, v162
    v_mfma_f32_16x16x32_bf16 v[78:81], a[112:115], v[8:11], v[78:81]
    v_cvt_pk_bf16_f32 v66, v74, v75
    v_cvt_pk_bf16_f32 v67, v76, v77
    v_mfma_f32_16x16x32_bf16 v[78:81], a[116:119], v[14:17], v[78:81]
    v_exp_f32 v163, v163
    v_mfma_f32_16x16x32_bf16 v[82:85], a[120:123], v[2:5], 0
    v_exp_f32 v164, v164
    v_mfma_f32_16x16x32_bf16 v[82:85], a[124:127], v[8:11], v[82:85]
    v_cvt_pk_bf16_f32 v68, v78, v79
    v_cvt_pk_bf16_f32 v69, v80, v81
    v_mfma_f32_16x16x32_bf16 v[82:85], a[128:131], v[14:17], v[82:85]
    v_exp_f32 v165, v165
    v_mfma_f32_16x16x32_bf16 v[76:79], a[132:135], v[2:5], 0
    v_exp_f32 v186, v186
    s_nop 1
    s_nop 0
    v_cvt_pk_bf16_f32 v74, v82, v83
    v_cvt_pk_bf16_f32 v75, v84, v85
    v_pk_add_f32 v[184:185], v[166:167], v[168:169]
    v_pk_add_f32 v[0:1], v[170:171], v[172:173]
    v_pk_add_f32 v[184:185], v[184:185], v[162:163]
    v_pk_add_f32 v[0:1], v[0:1], v[164:165]
    v_pk_add_f32 v[184:185], v[184:185], v[0:1]
    v_pk_mul_f32 v[166:167], v[166:167], v[54:55]
    v_pk_mul_f32 v[168:169], v[168:169], v[56:57]
    v_pk_mul_f32 v[170:171], v[170:171], v[58:59]
    v_pk_mul_f32 v[172:173], v[172:173], v[60:61]
    v_pk_mul_f32 v[162:163], v[162:163], v[62:63]
    v_pk_mul_f32 v[164:165], v[164:165], v[64:65]
    v_mfma_f32_16x16x32_bf16 v[76:79], a[136:139], v[8:11], v[76:79]
    v_add_f32 v184, v184, v185
    v_mov_b32 v185, v184
    v_mfma_f32_16x16x32_bf16 v[76:79], a[140:143], v[14:17], v[76:79]
    v_mfma_f32_16x16x32_bf16 v[62:65], v[38:41], a[0:3], 0
    v_mov_b64 v[56:57], v[252:253]
    v_mfma_f32_16x16x32_bf16 v[62:65], v[44:47], a[4:7], v[62:65]
    v_cvt_pk_bf16_f32 v76, v76, v77
    v_cvt_pk_bf16_f32 v77, v78, v79
    v_mfma_f32_16x16x32_bf16 v[62:65], v[50:53], a[8:11], v[62:65]
    v_permlane32_swap_b32 v184, v185
    v_mfma_f32_16x16x32_bf16 v[58:61], v[38:41], a[12:15], 0
    v_add_f32 v184, v184, v185
    v_mov_b32 v185, v184
    v_mfma_f32_16x16x32_bf16 v[58:61], v[44:47], a[16:19], v[58:61]
    v_cvt_pk_bf16_f32 v54, v62, v63
    v_cvt_pk_bf16_f32 v55, v64, v65
    v_mfma_f32_16x16x32_bf16 v[58:61], v[50:53], a[20:23], v[58:61]
    v_permlane16_swap_b32 v184, v185
    v_mfma_f32_16x16x32_bf16 v[78:81], v[2:5], v[70:73], 0
    v_add_f32 v184, v184, v185
    v_add_f32 v184, v184, v186
    v_mfma_f32_16x16x32_bf16 v[78:81], v[8:11], v[66:69], v[78:81]
    v_cvt_pk_bf16_f32 v58, v58, v59
    v_cvt_pk_bf16_f32 v59, v60, v61
    v_mfma_f32_16x16x32_bf16 v[78:81], v[14:17], v[74:77], v[78:81]
    v_rcp_f32 v184, v184
    v_mfma_f32_16x16x32_bf16 v[60:63], v[38:41], a[24:27], 0
    v_mov_b64 v[68:69], v[252:253]
    v_mul_f32 v166, v166, v184
    v_mfma_f32_16x16x32_bf16 v[60:63], v[44:47], a[28:31], v[60:63]
    v_cndmask_b32_dpp v13, v78, v13, vcc row_ror:8 row_mask:0xf bank_mask:0xf
    v_cndmask_b32_dpp v18, v79, v18, vcc row_ror:8 row_mask:0xf bank_mask:0xf
    v_mfma_f32_16x16x32_bf16 v[60:63], v[50:53], a[32:35], v[60:63]
    v_cndmask_b32_dpp v7, v80, v7, vcc row_ror:8 row_mask:0xf bank_mask:0xf
    v_cndmask_b32_dpp v12, v81, v12, vcc row_ror:8 row_mask:0xf bank_mask:0xf
    v_mfma_f32_16x16x32_bf16 v[70:73], v[38:41], a[36:39], 0
    s_mov_b64 vcc, s[38:39]
    v_mul_f32_dpp v0, v6, v13 quad_perm:[0,0,0,0] row_mask:0xf bank_mask:0xf
    v_mul_f32_dpp v192, v6, v18 quad_perm:[1,1,1,1] row_mask:0xf bank_mask:0xf
    v_mfma_f32_16x16x32_bf16 v[70:73], v[44:47], a[40:43], v[70:73]
    v_cvt_pk_bf16_f32 v66, v60, v61
    v_cvt_pk_bf16_f32 v67, v62, v63
    v_mfma_f32_16x16x32_bf16 v[70:73], v[50:53], a[44:47], v[70:73]
    v_mul_f32_dpp v196, v6, v7 quad_perm:[2,2,2,2] row_mask:0xf bank_mask:0xf
    v_mul_f32_dpp v185, v6, v12 quad_perm:[3,3,3,3] row_mask:0xf bank_mask:0xf
    v_mfma_f32_16x16x32_bf16 v[60:63], v[38:41], a[48:51], 0
    v_max3_f32 v1, v0, v192, v196
    v_max_f32 v1, v1, v185
    v_mfma_f32_16x16x32_bf16 v[60:63], v[44:47], a[52:55], v[60:63]
    v_cvt_pk_bf16_f32 v70, v70, v71
    v_cvt_pk_bf16_f32 v71, v72, v73
    v_mfma_f32_16x16x32_bf16 v[60:63], v[50:53], a[56:59], v[60:63]
    v_mul_f32_e64 v1, -v1, v6
    v_fma_f32 v0, v0, v6, v1
    v_mfma_f32_16x16x32_bf16 v[72:75], v[38:41], a[60:63], 0
    v_fma_f32 v192, v192, v6, v1
    v_fma_f32 v196, v196, v6, v1
    v_mfma_f32_16x16x32_bf16 v[72:75], v[44:47], a[64:67], v[72:75]
    v_cvt_pk_bf16_f32 v84, v60, v61
    v_cvt_pk_bf16_f32 v85, v62, v63
    v_mfma_f32_16x16x32_bf16 v[72:75], v[50:53], a[68:71], v[72:75]
    v_fma_f32 v185, v185, v6, v1
    v_mov_b64 v[86:87], v[252:253]
    v_mfma_f32_16x16x32_bf16 v[60:63], v[20:23], a[0:3], 0
    v_exp_f32 v0, v0
    v_mfma_f32_16x16x32_bf16 v[60:63], v[26:29], a[4:7], v[60:63]
    v_cvt_pk_bf16_f32 v88, v72, v73
    v_cvt_pk_bf16_f32 v89, v74, v75
    v_mfma_f32_16x16x32_bf16 v[60:63], v[32:35], a[8:11], v[60:63]
    v_exp_f32 v192, v192
    v_mfma_f32_16x16x32_bf16 v[76:79], v[20:23], a[12:15], 0
    v_exp_f32 v196, v196
    v_mfma_f32_16x16x32_bf16 v[76:79], v[26:29], a[16:19], v[76:79]
    v_cvt_pk_bf16_f32 v60, v60, v61
    v_cvt_pk_bf16_f32 v61, v62, v63
    v_mfma_f32_16x16x32_bf16 v[76:79], v[32:35], a[20:23], v[76:79]
    v_exp_f32 v185, v185
    v_mfma_f32_16x16x32_bf16 v[72:75], v[20:23], a[24:27], 0
    v_add_f32 v1, v0, v192
    v_add_f32 v7, v196, v185
    v_mfma_f32_16x16x32_bf16 v[72:75], v[26:29], a[28:31], v[72:75]
    v_cvt_pk_bf16_f32 v64, v76, v77
    v_cvt_pk_bf16_f32 v65, v78, v79
    v_mfma_f32_16x16x32_bf16 v[72:75], v[32:35], a[32:35], v[72:75]
    v_add_f32 v1, v1, v7
    v_mul_f32_dpp v0, v6, v0 quad_perm:[0,0,0,0] row_mask:0xf bank_mask:0xf
    v_mfma_f32_16x16x32_bf16 v[76:79], v[20:23], a[36:39], 0
    v_rcp_f32 v1, v1
    v_mfma_f32_16x16x32_bf16 v[76:79], v[26:29], a[40:43], v[76:79]
    v_mul_f32_dpp v192, v6, v192 quad_perm:[1,1,1,1] row_mask:0xf bank_mask:0xf
    v_mul_f32_dpp v196, v6, v196 quad_perm:[2,2,2,2] row_mask:0xf bank_mask:0xf
    v_mfma_f32_16x16x32_bf16 v[76:79], v[32:35], a[44:47], v[76:79]
    v_mul_f32_dpp v185, v6, v185 quad_perm:[3,3,3,3] row_mask:0xf bank_mask:0xf
    v_mul_f32 v0, v0, v1
    v_mfma_f32_16x16x32_bf16 v[80:83], v[20:23], a[48:51], 0
    v_mul_f32 v192, v192, v1
    v_mul_f32 v196, v196, v1
    v_mfma_f32_16x16x32_bf16 v[80:83], v[26:29], a[52:55], v[80:83]
    v_mul_f32 v185, v185, v1
    v_cvt_pk_bf16_f32 v1, v0, v192
    v_mfma_f32_16x16x32_bf16 v[80:83], v[32:35], a[56:59], v[80:83]
    v_cvt_pk_bf16_f32 v6, v196, v185
    v_and_b32 v36, v1, v225
    v_mfma_f32_16x16x32_bf16 v[174:177], v[20:23], a[60:63], 0
    v_and_b32 v37, v6, v225
    v_cvt_pk_bf16_f32 v72, v72, v73
    v_mfma_f32_16x16x32_bf16 v[174:177], v[26:29], a[64:67], v[174:177]
    v_cvt_pk_bf16_f32 v73, v74, v75
    v_mov_b64 v[42:43], v[36:37]
    v_mfma_f32_16x16x32_bf16 v[174:177], v[32:35], a[68:71], v[174:177]
    v_cvt_pk_bf16_f32 v76, v76, v77
    v_cvt_pk_bf16_f32 v77, v78, v79
    v_mfma_f32_16x16x32_bf16 v[188:191], v[54:57], v[36:39], 0
    v_cvt_pk_bf16_f32 v78, v80, v81
    v_cvt_pk_bf16_f32 v79, v82, v83
    v_mfma_f32_16x16x32_bf16 v[178:181], v[56:59], v[40:43], 0
    v_mov_b64 v[48:49], v[36:37]
    v_cvt_pk_bf16_f32 v82, v174, v175
    v_mfma_f32_16x16x32_bf16 v[38:41], v[66:69], v[42:45], 0
    v_cvt_pk_bf16_f32 v83, v176, v177
    v_cvt_pk_bf16_f32 v56, v188, v189
    v_mfma_f32_16x16x32_bf16 v[174:177], v[68:71], v[46:49], 0
    v_cvt_pk_bf16_f32 v57, v190, v191
    v_mov_b64 v[54:55], v[36:37]
    v_mfma_f32_16x16x32_bf16 v[42:45], v[84:87], v[48:51], 0
    v_cvt_pk_bf16_f32 v58, v178, v179
    v_cvt_pk_bf16_f32 v59, v180, v181
    v_mfma_f32_16x16x32_bf16 v[46:49], v[86:89], v[52:55], 0
    ds_write_b128 v232, v[56:59]
    v_cvt_pk_bf16_f32 v66, v38, v39
    v_cvt_pk_bf16_f32 v67, v40, v41
    v_mfma_f32_16x16x32_bf16 v[38:41], v[2:5], a[0:3], 0
    v_cvt_pk_bf16_f32 v68, v174, v175
    v_cvt_pk_bf16_f32 v69, v176, v177
    v_mfma_f32_16x16x32_bf16 v[38:41], v[8:11], a[4:7], v[38:41]
    ds_write_b128 v232, v[66:69] offset:64
    v_mfma_f32_16x16x32_bf16 v[38:41], v[14:17], a[8:11], v[38:41]
    v_cvt_pk_bf16_f32 v84, v42, v43
    v_cvt_pk_bf16_f32 v85, v44, v45
    v_mfma_f32_16x16x32_bf16 v[50:53], v[2:5], a[12:15], 0
    v_cvt_pk_bf16_f32 v86, v46, v47
    v_cvt_pk_bf16_f32 v87, v48, v49
    v_mfma_f32_16x16x32_bf16 v[50:53], v[8:11], a[16:19], v[50:53]
    ds_write_b128 v232, v[84:87] offset:128
    v_mfma_f32_16x16x32_bf16 v[50:53], v[14:17], a[20:23], v[50:53]
    v_cvt_pk_bf16_f32 v38, v38, v39
    v_cvt_pk_bf16_f32 v39, v40, v41
    v_mfma_f32_16x16x32_bf16 v[44:47], v[2:5], a[24:27], 0
    v_mov_b64 v[62:63], v[252:253]
    v_and_b32_dpp v18, v1, v225 row_ror:12 row_mask:0xf bank_mask:0xf
    v_mfma_f32_16x16x32_bf16 v[44:47], v[8:11], a[28:31], v[44:47]
    v_cvt_pk_bf16_f32 v42, v50, v51
    v_cvt_pk_bf16_f32 v43, v52, v53
    v_mfma_f32_16x16x32_bf16 v[44:47], v[14:17], a[32:35], v[44:47]
    v_and_b32_dpp v19, v6, v225 row_ror:12 row_mask:0xf bank_mask:0xf
    v_mov_b64 v[24:25], v[18:19]
    v_mfma_f32_16x16x32_bf16 v[48:51], v[2:5], a[36:39], 0
    v_mov_b64 v[74:75], v[252:253]
    v_mov_b64 v[30:31], v[18:19]
    v_mfma_f32_16x16x32_bf16 v[48:51], v[8:11], a[40:43], v[48:51]
    v_cvt_pk_bf16_f32 v44, v44, v45
    v_cvt_pk_bf16_f32 v45, v46, v47
    v_mfma_f32_16x16x32_bf16 v[48:51], v[14:17], a[44:47], v[48:51]
    v_mov_b64 v[80:81], v[252:253]
    v_mov_b64 v[36:37], v[18:19]
    v_mfma_f32_16x16x32_bf16 v[174:177], v[2:5], a[48:51], 0
    v_mov_b64 v[40:41], v[252:253]
    v_mov_b64 v[46:47], v[252:253]
    v_mfma_f32_16x16x32_bf16 v[174:177], v[8:11], a[52:55], v[174:177]
    v_cvt_pk_bf16_f32 v48, v48, v49
    v_cvt_pk_bf16_f32 v49, v50, v51
    v_mfma_f32_16x16x32_bf16 v[174:177], v[14:17], a[56:59], v[174:177]
    v_mov_b64 v[52:53], v[252:253]
    v_fmac_f32_dpp v183, v187, v0 quad_perm:[0,0,0,0] row_mask:0xf bank_mask:0xf
    v_mfma_f32_16x16x32_bf16 v[178:181], v[2:5], a[60:63], 0
    v_and_b32_dpp v0, v1, v225 row_ror:8 row_mask:0xf bank_mask:0xf
    v_and_b32_dpp v1, v6, v225 row_ror:8 row_mask:0xf bank_mask:0xf
    v_mfma_f32_16x16x32_bf16 v[178:181], v[8:11], a[64:67], v[178:181]
    v_cvt_pk_bf16_f32 v50, v174, v175
    v_cvt_pk_bf16_f32 v51, v176, v177
    v_mfma_f32_16x16x32_bf16 v[178:181], v[14:17], a[68:71], v[178:181]
    v_mov_b64 v[6:7], v[0:1]
    v_mov_b64 v[12:13], v[0:1]
    v_mfma_f32_16x16x32_bf16 v[188:191], v[60:63], v[18:21], 0
    v_mov_b64 v[18:19], v[0:1]
    v_fmac_f32_dpp v183, v187, v192 quad_perm:[1,1,1,1] row_mask:0xf bank_mask:0xf
    v_mfma_f32_16x16x32_bf16 v[192:195], v[62:65], v[22:25], 0
    v_cvt_pk_bf16_f32 v54, v178, v179
    v_cvt_pk_bf16_f32 v55, v180, v181
    v_mfma_f32_16x16x32_bf16 v[174:177], v[72:75], v[24:27], 0
    v_cvt_pk_bf16_f32 v20, v188, v189
    v_cvt_pk_bf16_f32 v21, v190, v191
    v_mfma_f32_16x16x32_bf16 v[178:181], v[74:77], v[28:31], 0
    v_cvt_pk_bf16_f32 v22, v192, v193
    v_cvt_pk_bf16_f32 v23, v194, v195
    v_mfma_f32_16x16x32_bf16 v[70:73], v[78:81], v[30:33], 0
    ds_write_b128 v233, v[20:23]
    v_mfma_f32_16x16x32_bf16 v[60:63], v[80:83], v[34:37], 0
    v_cvt_pk_bf16_f32 v24, v174, v175
    v_cvt_pk_bf16_f32 v25, v176, v177
    v_mfma_f32_16x16x32_bf16 v[28:31], v[56:59], v[56:59], 0
    v_cvt_pk_bf16_f32 v26, v178, v179
    v_cvt_pk_bf16_f32 v27, v180, v181
    v_mfma_f32_16x16x32_bf16 v[28:31], v[66:69], v[66:69], v[28:31]
    ds_write_b128 v233, v[24:27] offset:64
    v_mfma_f32_16x16x32_bf16 v[28:31], v[84:87], v[84:87], v[28:31]
    v_cvt_pk_bf16_f32 v32, v70, v71
    v_cvt_pk_bf16_f32 v33, v72, v73
    v_mfma_f32_16x16x32_bf16 v[56:59], v[38:41], v[0:3], 0
    v_cvt_pk_bf16_f32 v34, v60, v61
    v_cvt_pk_bf16_f32 v35, v62, v63
    v_mfma_f32_16x16x32_bf16 v[36:39], v[40:43], v[4:7], 0
    ds_write_b128 v233, v[32:35] offset:128
    v_mfma_f32_16x16x32_bf16 v[0:3], v[44:47], v[6:9], 0
    v_cvt_pk_bf16_f32 v44, v56, v57
    v_cvt_pk_bf16_f32 v45, v58, v59
    v_mfma_f32_16x16x32_bf16 v[40:43], v[46:49], v[10:13], 0
    v_cvt_pk_bf16_f32 v46, v36, v37
    v_cvt_pk_bf16_f32 v47, v38, v39
    v_mfma_f32_16x16x32_bf16 v[36:39], v[50:53], v[12:15], 0
    ds_write_b128 v234, v[44:47]
    v_mfma_f32_16x16x32_bf16 v[6:9], v[52:55], v[16:19], 0
    v_cndmask_b32_e64 v28, v28, v29, s[32:33]
    v_cndmask_b32_e64 v28, v28, v30, s[34:35]
    v_mfma_f32_16x16x32_bf16 v[10:13], v[20:23], v[20:23], 0
    v_cndmask_b32_e64 v28, v28, v31, s[36:37]
    v_fmac_f32_dpp v183, v187, v196 quad_perm:[2,2,2,2] row_mask:0xf bank_mask:0xf
    v_mfma_f32_16x16x32_bf16 v[10:13], v[24:27], v[24:27], v[10:13]
    v_fmac_f32_dpp v183, v187, v185 quad_perm:[3,3,3,3] row_mask:0xf bank_mask:0xf
    v_mul_f32_e64 v20, v183, v183
    v_mfma_f32_16x16x32_bf16 v[10:13], v[32:35], v[32:35], v[10:13]
    v_cvt_pk_bf16_f32 v16, v0, v1
    v_cvt_pk_bf16_f32 v17, v2, v3
    v_mfma_f32_16x16x32_bf16 v[2:5], v[44:47], v[44:47], 0
    v_cvt_pk_bf16_f32 v18, v40, v41
    v_cvt_pk_bf16_f32 v19, v42, v43
    v_cvt_pk_bf16_f32 v14, v36, v37
    v_cndmask_b32_e64 v0, v10, v11, s[32:33]
    v_mfma_f32_16x16x32_bf16 v[2:5], v[16:19], v[16:19], v[2:5]
    ds_write_b128 v234, v[16:19] offset:64
    v_cndmask_b32_e64 v0, v0, v12, s[34:35]
    v_cndmask_b32_e64 v0, v0, v13, s[36:37]
    v_cvt_pk_bf16_f32 v15, v38, v39
    v_cvt_pk_bf16_f32 v16, v6, v7
    v_cndmask_b32_dpp v6, v0, v28, vcc row_ror:4 row_mask:0xf bank_mask:0xf
    s_mov_b64 vcc, s[40:41]
    v_cvt_pk_bf16_f32 v17, v8, v9
    ds_write_b128 v234, v[14:17] offset:128
    v_mul_f32 v167, v167, v184
    v_mfma_f32_16x16x32_bf16 v[2:5], v[14:17], v[14:17], v[2:5]
    v_mul_f32 v168, v168, v184
    v_mul_f32 v169, v169, v184
    v_mul_f32 v170, v170, v184
    v_mul_f32 v171, v171, v184
    v_mul_f32 v172, v172, v184
    v_mul_f32 v173, v173, v184
    v_cvt_pk_bf16_f32 v0, v166, v167
    v_cndmask_b32_e64 v3, v2, v3, s[32:33]
    v_cndmask_b32_e64 v3, v3, v4, s[34:35]
    v_cndmask_b32_e64 v3, v3, v5, s[36:37]
    v_cvt_pk_bf16_f32 v1, v168, v169
    v_cvt_pk_bf16_f32 v2, v170, v171
    v_cndmask_b32_dpp v6, v3, v6, vcc row_ror:8 row_mask:0xf bank_mask:0xf
    v_fmamk_f32 v20, v20, 0xbc2aaaab, v6
    v_add_f32_e64 v20, |v20|, s51
    v_rsq_f32 v4, v20
    v_cvt_pk_bf16_f32 v3, v172, v173
    ds_write_b32 v235, v4
    s_waitcnt vmcnt(6)
    ds_add_u32 v210, v225
    v_mfma_f32_16x16x32_bf16 v[8:11], v[102:105], v[0:3], 0
    v_mul_f32 v186, v186, v208
    v_mul_f32 v186, v186, v184
    v_mul_f32 v162, v162, v184
    v_mul_f32 v163, v163, v184
    v_mul_f32 v164, v164, v184
    v_mul_f32 v165, v165, v184
    v_cvt_pk_bf16_f32 v186, v186, v186
    v_cvt_pk_bf16_f32 v4, v162, v163
    v_cvt_pk_bf16_f32 v5, v164, v165
    v_and_b32 v6, v186, v236
    v_and_b32 v7, v186, v237
    v_lshl_add_u64 v[232:233], v[232:233], 0, s[56:57]
    v_lshl_add_u64 v[234:235], v[234:235], 0, s[56:57]
    v_mfma_f32_16x16x32_bf16 v[8:11], v[114:117], v[4:7], v[8:11]
    v_mfma_f32_16x16x32_bf16 v[8:11], v[252:255], v[98:101], v[8:11]
    v_mfma_f32_16x16x32_bf16 v[12:15], v[106:109], v[0:3], 0
    v_mfma_f32_16x16x32_bf16 v[12:15], v[122:125], v[4:7], v[12:15]
    ds_read_b128 v[40:43], v229
    ds_read_b32 v45, v224
    v_mfma_f32_16x16x32_bf16 v[12:15], v[250:253], v[98:101], v[12:15]
    ds_read_b128 v[36:39], v222
    v_cvt_pk_bf16_f32 v20, v8, v9
    v_mfma_f32_16x16x32_bf16 v[16:19], v[110:113], v[0:3], 0
    ds_read_b128 v[32:35], v222 offset:64
    v_cvt_pk_bf16_f32 v21, v10, v11
    v_mfma_f32_16x16x32_bf16 v[16:19], v[126:129], v[4:7], v[16:19]
    s_waitcnt lgkmcnt(14)
    ds_read_b128 v[28:31], v222 offset:128
    v_cvt_pk_bf16_f32 v22, v12, v13
    v_mfma_f32_16x16x32_bf16 v[16:19], v[252:255], v[94:97], v[16:19]
    s_waitcnt lgkmcnt(14)
    ds_read_b32 v24, v210
    v_cvt_pk_bf16_f32 v23, v14, v15
    v_mfma_f32_16x16x32_bf16 v[8:11], v[118:121], v[0:3], 0
    s_waitcnt lgkmcnt(14)
    ds_write_b128 v226, v[20:23] offset:6144
    v_mfma_f32_16x16x32_bf16 v[8:11], v[134:137], v[4:7], v[8:11]
    v_cvt_pk_bf16_f32 v16, v16, v17
    v_cvt_pk_bf16_f32 v17, v18, v19
    v_mfma_f32_16x16x32_bf16 v[8:11], v[250:253], v[94:97], v[8:11]
    v_lshl_add_u64 v[228:229], v[228:229], 0, s[58:59]
    v_lshl_add_u64 v[222:223], v[222:223], 0, s[60:61]
    v_mfma_f32_16x16x32_bf16 v[12:15], v[130:133], v[0:3], 0
    v_add_u32 v224, 2320, v224
    v_mfma_f32_16x16x32_bf16 v[12:15], v[138:141], v[4:7], v[12:15]
    v_cvt_pk_bf16_f32 v18, v8, v9
    v_cvt_pk_bf16_f32 v19, v10, v11
    v_mfma_f32_16x16x32_bf16 v[12:15], v[252:255], v[90:93], v[12:15]
    s_waitcnt lgkmcnt(14)
    ds_write_b128 v226, v[16:19] offset:6208
    v_mfma_f32_16x16x32_bf16 v[16:19], v[146:149], v[0:3], 0
    s_waitcnt lgkmcnt(2)
    v_readfirstlane_b32 s63, v24
    s_cmp_gt_i32 s63, s62
    v_mfma_f32_16x16x32_bf16 v[16:19], v[142:145], v[4:7], v[16:19]
    s_cbranch_scc1 L_spin
L_spin_back:
    ds_read_b128 v[0:3], v209
    s_sub_u32 s62, s62, 4
    v_mfma_f32_16x16x32_bf16 v[16:19], v[250:253], v[90:93], v[16:19]
    s_add_u32 s23, s23, 256
    ds_read_b128 v[8:11], v209 offset:64
    s_cmp_lt_u32 s23, s3
    ds_read_b128 v[4:7], v209 offset:128
    v_cvt_pk_bf16_f32 v12, v12, v13
    v_cvt_pk_bf16_f32 v13, v14, v15
    s_cselect_b32 s6, 109734912, 0
    s_cselect_b32 s47, s23, s53
    v_cvt_pk_bf16_f32 v14, v16, v17
    v_cvt_pk_bf16_f32 v15, v18, v19
    s_mul_hi_u32 s48, s47, 79536432
    s_mul_i32 s49, s48, 54
    ds_write_b128 v226, v[12:15] offset:6272
    s_sub_u32 s49, s47, s49
    s_mul_i32 s48, s48, 508032
    s_mul_i32 s49, s49, 1344
    v_lshl_add_u64 v[226:227], v[226:227], 0, s[58:59]
    s_add_u32 s24, s48, s49
    s_sub_u32 s22, s22, 1
    s_add_u32 s55, s55, 1
    s_sub_u32 s46, s55, 8
    s_cmp_lt_u32 s46, 2
    s_waitcnt lgkmcnt(0)
    s_cbranch_scc1 L_claim
    s_cmp_lg_u32 s22, 0
    s_cbranch_scc1 L_loop
    v_mfma_f32_16x16x32_bf16 v[12:15], a[144:147], v[0:3], 0
    ds_read_b128 v[82:85], v230 offset:6144
    ds_read_b128 v[78:81], v230 offset:7168
    v_mfma_f32_16x16x32_bf16 v[12:15], a[148:151], v[8:11], v[12:15]
    ds_read_b128 v[62:65], v226 offset:3072
    v_mov_b32_dpp v150, v158 quad_perm:[0,1,2,3] row_mask:0xf bank_mask:0x2
    v_mfma_f32_16x16x32_bf16 v[12:15], a[152:155], v[4:7], v[12:15]
    ds_read_b128 v[58:61], v226 offset:3136
    v_mov_b32_dpp v151, v159 quad_perm:[0,1,2,3] row_mask:0xf bank_mask:0x2
    v_mfma_f32_16x16x32_bf16 v[46:49], a[156:159], v[0:3], 0
    ds_read_b128 v[24:27], v226 offset:3200
    v_mov_b32_dpp v152, v160 quad_perm:[0,1,2,3] row_mask:0xf bank_mask:0x2
    v_mfma_f32_16x16x32_bf16 v[46:49], a[160:163], v[8:11], v[46:49]
    ds_read_b128 v[20:23], v226 offset:6144
    v_cvt_pk_bf16_f32 v98, v12, v13
    v_mfma_f32_16x16x32_bf16 v[46:49], a[164:167], v[4:7], v[46:49]
    ds_read_b128 v[16:19], v226 offset:6208
    v_cvt_pk_bf16_f32 v99, v14, v15
    v_mfma_f32_16x16x32_bf16 v[50:53], a[168:171], v[0:3], 0
    ds_read_b128 v[12:15], v226 offset:6272
    v_mov_b32_dpp v153, v161 quad_perm:[0,1,2,3] row_mask:0xf bank_mask:0x2
    v_mfma_f32_16x16x32_bf16 v[50:53], a[172:175], v[8:11], v[50:53]
    ds_read_b128 v[66:69], v222
    v_cvt_pk_bf16_f32 v100, v46, v47
    v_mfma_f32_16x16x32_bf16 v[50:53], a[176:179], v[4:7], v[50:53]
    ds_read_b32 v170, v228
    v_cvt_pk_bf16_f32 v101, v48, v49
    v_mfma_f32_16x16x32_bf16 v[90:93], a[180:183], v[0:3], 0
    ds_read_b128 v[70:73], v222 offset:64
    v_mov_b32_dpp v150, v154 quad_perm:[0,1,2,3] row_mask:0xf bank_mask:0x4
    v_mfma_f32_16x16x32_bf16 v[90:93], a[184:187], v[8:11], v[90:93]
    ds_read_b128 v[74:77], v222 offset:128
    v_cvt_pk_bf16_f32 v158, v50, v51
    v_mfma_f32_16x16x32_bf16 v[90:93], a[188:191], v[4:7], v[90:93]
    ds_read_b128 v[46:49], v227
    v_cvt_pk_bf16_f32 v159, v52, v53
    v_mfma_f32_16x16x32_bf16 v[86:89], a[192:195], v[0:3], 0
    ds_read_b128 v[50:53], v227 offset:64
    v_mov_b32_dpp v151, v155 quad_perm:[0,1,2,3] row_mask:0xf bank_mask:0x4
    v_mfma_f32_16x16x32_bf16 v[86:89], a[196:199], v[8:11], v[86:89]
    ds_read_b128 v[54:57], v227 offset:128
    v_cvt_pk_bf16_f32 v160, v90, v91
    v_mfma_f32_16x16x32_bf16 v[86:89], a[200:203], v[4:7], v[86:89]
    s_waitcnt lgkmcnt(14)
    ds_read_b32 v186, v224
    v_cvt_pk_bf16_f32 v161, v92, v93
    v_mfma_f32_16x16x32_bf16 v[94:97], a[204:207], v[0:3], 0
    buffer_store_dwordx4 v[82:85], v218, s[8:11], s27 offen nt
    v_mfma_f32_16x16x32_bf16 v[94:97], a[208:211], v[8:11], v[94:97]
    s_waitcnt lgkmcnt(14)
    ds_read_b128 v[166:169], v230 offset:8192
    v_mov_b32_dpp v152, v156 quad_perm:[0,1,2,3] row_mask:0xf bank_mask:0x4
    v_mfma_f32_16x16x32_bf16 v[94:97], a[212:215], v[4:7], v[94:97]
    s_waitcnt lgkmcnt(14)
    v_mov_b32_dpp v153, v157 quad_perm:[0,1,2,3] row_mask:0xf bank_mask:0x4
    v_mul_f32 v150, v150, v40
    v_mfma_f32_16x16x32_bf16 v[90:93], a[144:147], v[62:65], 0
    s_waitcnt lgkmcnt(13)
    v_mul_f32 v151, v151, v41
    v_mul_f32 v152, v152, v42
    v_mfma_f32_16x16x32_bf16 v[90:93], a[148:151], v[58:61], v[90:93]
    s_waitcnt lgkmcnt(12)
    v_mul_f32 v153, v153, v43
    v_mul_f32 v182, v182, v45
    v_mfma_f32_16x16x32_bf16 v[90:93], a[152:155], v[24:27], v[90:93]
    buffer_store_dwordx4 v[78:81], v219, s[8:11], s27 offen nt
    v_mfma_f32_16x16x32_bf16 v[154:157], a[156:159], v[62:65], 0
    v_max3_f32 v44, v150, v151, v152
    v_max3_f32 v44, v44, v153, v182
    v_mfma_f32_16x16x32_bf16 v[154:157], a[160:163], v[58:61], v[154:157]
    v_cvt_pk_bf16_f32 v162, v86, v87
    v_max_f32_dpp v44, v44, v44 row_ror:4 row_mask:0xf bank_mask:0xf
    v_mfma_f32_16x16x32_bf16 v[154:157], a[164:167], v[24:27], v[154:157]
    v_cvt_pk_bf16_f32 v163, v88, v89
    v_max_f32_dpp v44, v44, v44 row_ror:8 row_mask:0xf bank_mask:0xf
    v_mfma_f32_16x16x32_bf16 v[82:85], v[0:3], v[98:101], 0
    v_mov_b32 v78, v44
    v_cvt_pk_bf16_f32 v164, v94, v95
    v_mfma_f32_16x16x32_bf16 v[82:85], v[8:11], v[158:161], v[82:85]
    s_waitcnt lgkmcnt(0)
    buffer_store_dwordx4 v[166:169], v220, s[8:11], s27 offen nt
    v_permlane32_swap_b32 v44, v78
    v_cvt_pk_bf16_f32 v165, v96, v97
    v_max_f32 v44, v44, v78
    v_mov_b32 v78, v44
    v_mfma_f32_16x16x32_bf16 v[82:85], v[4:7], v[162:165], v[82:85]
    v_cvt_pk_bf16_f32 v90, v90, v91
    v_permlane16_swap_b32 v44, v78
    v_mfma_f32_16x16x32_bf16 v[86:89], v[62:65], v[98:101], 0
    v_max_f32 v44, v44, v78
    v_mul_f32_e64 v44, -v44, v45
    v_mfma_f32_16x16x32_bf16 v[86:89], v[58:61], v[158:161], v[86:89]
    v_fma_f32 v150, v150, v45, v44
    v_fma_f32 v151, v151, v45, v44
    v_mfma_f32_16x16x32_bf16 v[86:89], v[24:27], v[162:165], v[86:89]
    v_fma_f32 v152, v152, v45, v44
    v_fma_f32 v153, v153, v45, v44
    v_mfma_f32_16x16x32_bf16 v[78:81], v[20:23], v[98:101], 0
    v_exp_f32 v150, v150
    v_mfma_f32_16x16x32_bf16 v[78:81], v[16:19], v[158:161], v[78:81]
    v_exp_f32 v151, v151
    v_mfma_f32_16x16x32_bf16 v[78:81], v[12:15], v[162:165], v[78:81]
    v_exp_f32 v152, v152
    v_mfma_f32_16x16x32_bf16 v[94:97], v[66:69], v[98:101], 0
    v_exp_f32 v153, v153
    v_mfma_f32_16x16x32_bf16 v[94:97], v[70:73], v[158:161], v[94:97]
    v_add_f32 v98, v150, v151
    v_add_f32 v91, v152, v153
    v_mfma_f32_16x16x32_bf16 v[94:97], v[74:77], v[162:165], v[94:97]
    v_add_f32 v98, v98, v91
    v_fma_f32 v182, v182, v45, v44
    v_exp_f32 v182, v182
    v_add_f32_dpp v91, v98, v98 row_shl:4 row_mask:0xf bank_mask:0xf bound_ctrl:0
    v_add_f32_dpp v98, v98, v91 row_shl:8 row_mask:0xf bank_mask:0xf bound_ctrl:0
    v_mov_b32 v91, v98
    v_mul_f32 v150, v150, v40
    v_mul_f32 v151, v151, v41
    v_permlane32_swap_b32 v98, v91
    v_add_f32 v98, v98, v91
    v_mov_b32 v91, v98
    v_mul_f32 v152, v152, v42
    v_mul_f32 v153, v153, v43
    v_permlane16_swap_b32 v98, v91
    v_add_f32 v98, v98, v91
    v_add_f32 v98, v98, v182
    v_rcp_f32 v98, v98
    v_mul_f32 v182, v182, v45
    v_cvt_pk_bf16_f32 v91, v92, v93
    v_mul_f32_dpp v150, v98, v150 row_newbcast:0 row_mask:0xf bank_mask:0xf
    v_mul_f32_dpp v151, v98, v151 row_newbcast:0 row_mask:0xf bank_mask:0xf
    v_mul_f32_dpp v152, v98, v152 row_newbcast:0 row_mask:0xf bank_mask:0xf
    v_mul_f32_dpp v153, v98, v153 row_newbcast:0 row_mask:0xf bank_mask:0xf
    v_cvt_pk_bf16_f32 v40, v150, v151
    v_cvt_pk_bf16_f32 v41, v152, v153
    v_mul_f32_dpp v182, v98, v182 row_newbcast:0 row_mask:0xf bank_mask:0xf
    v_mov_b32_dpp v42, v40 row_shl:4 row_mask:0xf bank_mask:0xf bound_ctrl:0
    v_mov_b32_dpp v43, v41 row_shl:4 row_mask:0xf bank_mask:0xf bound_ctrl:0
    v_cvt_pk_bf16_f32 v182, v182, v182
    v_mov_b32_dpp v96, v40 row_shl:8 row_mask:0xf bank_mask:0xf bound_ctrl:0
    v_mfma_f32_16x16x32_bf16 v[150:153], v[102:105], v[40:43], 0
    v_mov_b32_dpp v97, v41 row_shl:8 row_mask:0xf bank_mask:0xf bound_ctrl:0
    v_and_b32 v98, v182, v236
    v_and_b32 v99, v182, v237
    v_cvt_pk_bf16_f32 v92, v154, v155
    v_cvt_pk_bf16_f32 v93, v156, v157
    v_mfma_f32_16x16x32_bf16 v[150:153], v[114:117], v[96:99], v[150:153]
    v_mul_f32 v82, v82, v46
    v_mul_f32 v83, v83, v47
    v_mfma_f32_16x16x32_bf16 v[150:153], v[252:255], v[36:39], v[150:153]
    v_mul_f32 v84, v84, v48
    v_mul_f32 v85, v85, v49
    v_mfma_f32_16x16x32_bf16 v[100:103], v[106:109], v[40:43], 0
    v_mul_f32 v86, v86, v50
    v_mul_f32 v87, v87, v51
    v_mfma_f32_16x16x32_bf16 v[100:103], v[122:125], v[96:99], v[100:103]
    v_cvt_pk_bf16_f32 v108, v150, v151
    v_cvt_pk_bf16_f32 v109, v152, v153
    v_mfma_f32_16x16x32_bf16 v[100:103], v[250:253], v[36:39], v[100:103]
    v_mul_f32 v88, v88, v52
    v_mul_f32 v89, v89, v53
    v_mfma_f32_16x16x32_bf16 v[104:107], v[110:113], v[40:43], 0
    v_max3_f32 v44, v82, v83, v84
    v_mul_f32 v78, v78, v54
    v_mfma_f32_16x16x32_bf16 v[104:107], v[126:129], v[96:99], v[104:107]
    v_cvt_pk_bf16_f32 v110, v100, v101
    v_cvt_pk_bf16_f32 v111, v102, v103
    v_mfma_f32_16x16x32_bf16 v[104:107], v[252:255], v[32:35], v[104:107]
    buffer_store_dwordx4 v[108:111], v221, s[8:11], s27 offen offset:0 nt
    v_mfma_f32_16x16x32_bf16 v[36:39], v[118:121], v[40:43], 0
    v_mul_f32 v79, v79, v55
    v_mul_f32 v80, v80, v56
    v_mfma_f32_16x16x32_bf16 v[36:39], v[134:137], v[96:99], v[36:39]
    v_cvt_pk_bf16_f32 v100, v104, v105
    v_cvt_pk_bf16_f32 v101, v106, v107
    v_mfma_f32_16x16x32_bf16 v[36:39], v[250:253], v[32:35], v[36:39]
    v_mul_f32 v81, v81, v57
    v_max3_f32 v45, v85, v86, v87
    v_mfma_f32_16x16x32_bf16 v[32:35], v[130:133], v[40:43], 0
    v_max3_f32 v44, v44, v88, v89
    v_mul_f32 v94, v94, v186
    v_mfma_f32_16x16x32_bf16 v[32:35], v[138:141], v[96:99], v[32:35]
    v_cvt_pk_bf16_f32 v102, v36, v37
    v_cvt_pk_bf16_f32 v103, v38, v39
    v_mfma_f32_16x16x32_bf16 v[32:35], v[252:255], v[28:31], v[32:35]
    buffer_store_dwordx4 v[100:103], v221, s[8:11], s27 offen offset:64 nt
    v_mfma_f32_16x16x32_bf16 v[36:39], v[146:149], v[40:43], 0
    v_max3_f32 v45, v45, v78, v79
    v_max3_f32 v44, v44, v80, v81
    v_mfma_f32_16x16x32_bf16 v[36:39], v[142:145], v[96:99], v[36:39]
    v_cvt_pk_bf16_f32 v40, v32, v33
    v_cvt_pk_bf16_f32 v41, v34, v35
    v_mfma_f32_16x16x32_bf16 v[36:39], v[250:253], v[28:31], v[36:39]
    v_max3_f32 v44, v44, v45, v94
    v_mov_b32 v45, v44
    v_mfma_f32_16x16x32_bf16 v[28:31], a[168:171], v[62:65], 0
    v_add_u32 v230, s42, v230
    v_mfma_f32_16x16x32_bf16 v[28:31], a[172:175], v[58:61], v[28:31]
    v_cvt_pk_bf16_f32 v42, v36, v37
    v_cvt_pk_bf16_f32 v43, v38, v39
    v_mfma_f32_16x16x32_bf16 v[28:31], a[176:179], v[24:27], v[28:31]
    buffer_store_dwordx4 v[40:43], v221, s[8:11], s27 offen offset:128 nt
    v_mfma_f32_16x16x32_bf16 v[32:35], a[180:183], v[62:65], 0
    s_mov_b32 s10, 109734912
    v_permlane32_swap_b32 v44, v45
    v_mfma_f32_16x16x32_bf16 v[32:35], a[184:187], v[58:61], v[32:35]
    v_cvt_pk_bf16_f32 v40, v28, v29
    v_cvt_pk_bf16_f32 v41, v30, v31
    v_mfma_f32_16x16x32_bf16 v[32:35], a[188:191], v[24:27], v[32:35]
    v_max_f32 v44, v44, v45
    v_mov_b32 v45, v44
    v_mfma_f32_16x16x32_bf16 v[36:39], a[192:195], v[62:65], 0
    v_mfma_f32_16x16x32_bf16 v[36:39], a[196:199], v[58:61], v[36:39]
    v_cvt_pk_bf16_f32 v42, v32, v33
    v_cvt_pk_bf16_f32 v43, v34, v35
    v_mfma_f32_16x16x32_bf16 v[36:39], a[200:203], v[24:27], v[36:39]
    v_permlane16_swap_b32 v44, v45
    v_mfma_f32_16x16x32_bf16 v[28:31], a[204:207], v[62:65], 0
    v_max_f32 v44, v44, v45
    v_mul_f32_e64 v171, -v44, v170
    v_mfma_f32_16x16x32_bf16 v[28:31], a[208:211], v[58:61], v[28:31]
    v_cvt_pk_bf16_f32 v106, v36, v37
    v_cvt_pk_bf16_f32 v107, v38, v39
    v_mfma_f32_16x16x32_bf16 v[28:31], a[212:215], v[24:27], v[28:31]
    ds_read_b32 v44, v228 offset:64
    v_fma_f32 v82, v82, v170, v171
    v_mfma_f32_16x16x32_bf16 v[32:35], v[0:3], a[216:219], 0
    v_fma_f32 v83, v83, v170, v171
    v_fma_f32 v84, v84, v170, v171
    v_mfma_f32_16x16x32_bf16 v[32:35], v[8:11], a[220:223], v[32:35]
    v_cvt_pk_bf16_f32 v108, v28, v29
    v_cvt_pk_bf16_f32 v109, v30, v31
    v_mfma_f32_16x16x32_bf16 v[32:35], v[4:7], a[224:227], v[32:35]
    v_fma_f32 v85, v85, v170, v171
    v_fma_f32 v86, v86, v170, v171
    v_mfma_f32_16x16x32_bf16 v[28:31], v[62:65], a[216:219], 0
    v_fma_f32 v87, v87, v170, v171
    v_fma_f32 v88, v88, v170, v171
    v_mfma_f32_16x16x32_bf16 v[28:31], v[58:61], a[220:223], v[28:31]
    v_cvt_pk_bf16_f32 v102, v32, v33
    v_cvt_pk_bf16_f32 v103, v34, v35
    v_mfma_f32_16x16x32_bf16 v[28:31], v[24:27], a[224:227], v[28:31]
    v_fma_f32 v89, v89, v170, v171
    v_fma_f32 v78, v78, v170, v171
    v_mfma_f32_16x16x32_bf16 v[36:39], v[20:23], a[216:219], 0
    v_fma_f32 v79, v79, v170, v171
    v_fma_f32 v80, v80, v170, v171
    v_mfma_f32_16x16x32_bf16 v[36:39], v[16:19], a[220:223], v[36:39]
    v_cvt_pk_bf16_f32 v104, v28, v29
    v_cvt_pk_bf16_f32 v105, v30, v31
    v_mfma_f32_16x16x32_bf16 v[36:39], v[12:15], a[224:227], v[36:39]
    v_fma_f32 v81, v81, v170, v171
    v_fma_f32 v94, v94, v170, v171
    v_mfma_f32_16x16x32_bf16 v[32:35], v[0:3], v[90:93], 0
    v_exp_f32 v82, v82
    v_mfma_f32_16x16x32_bf16 v[32:35], v[8:11], v[40:43], v[32:35]
    v_cvt_pk_bf16_f32 v114, v36, v37
    v_cvt_pk_bf16_f32 v115, v38, v39
    v_mfma_f32_16x16x32_bf16 v[32:35], v[4:7], v[106:109], v[32:35]
    v_exp_f32 v83, v83
    v_mfma_f32_16x16x32_bf16 v[36:39], v[62:65], v[90:93], 0
    v_exp_f32 v84, v84
    v_mfma_f32_16x16x32_bf16 v[36:39], v[58:61], v[40:43], v[36:39]
    v_exp_f32 v85, v85
    v_mfma_f32_16x16x32_bf16 v[36:39], v[24:27], v[106:109], v[36:39]
    v_exp_f32 v86, v86
    v_mfma_f32_16x16x32_bf16 v[28:31], v[20:23], v[90:93], 0
    v_exp_f32 v87, v87
    v_mfma_f32_16x16x32_bf16 v[28:31], v[16:19], v[40:43], v[28:31]
    v_exp_f32 v88, v88
    v_mfma_f32_16x16x32_bf16 v[28:31], v[12:15], v[106:109], v[28:31]
    v_exp_f32 v89, v89
    v_mfma_f32_16x16x32_bf16 v[98:101], v[66:69], v[90:93], 0
    v_exp_f32 v78, v78
    v_mfma_f32_16x16x32_bf16 v[98:101], v[70:73], v[40:43], v[98:101]
    ds_read_b128 v[40:43], v231 offset:9216
    v_mul_f32 v32, v32, v46
    v_mfma_f32_16x16x32_bf16 v[98:101], v[74:77], v[106:109], v[98:101]
    ds_read_b128 v[90:93], v231 offset:11264
    v_mul_f32 v33, v33, v47
    v_mfma_f32_16x16x32_bf16 v[106:109], v[0:3], a[228:231], 0
    v_exp_f32 v79, v79
    v_mfma_f32_16x16x32_bf16 v[106:109], v[8:11], a[232:235], v[106:109]
    v_exp_f32 v80, v80
    v_mfma_f32_16x16x32_bf16 v[106:109], v[4:7], a[236:239], v[106:109]
    v_exp_f32 v81, v81
    v_exp_f32 v94, v94
    v_mul_f32 v34, v34, v48
    v_pk_add_f32 v[96:97], v[82:83], v[84:85]
    v_pk_add_f32 v[100:101], v[86:87], v[88:89]
    v_pk_add_f32 v[96:97], v[96:97], v[78:79]
    v_pk_add_f32 v[100:101], v[100:101], v[80:81]
    v_pk_add_f32 v[96:97], v[96:97], v[100:101]
    v_pk_mul_f32 v[82:83], v[82:83], v[46:47]
    v_pk_mul_f32 v[84:85], v[84:85], v[48:49]
    v_pk_mul_f32 v[86:87], v[86:87], v[50:51]
    v_pk_mul_f32 v[88:89], v[88:89], v[52:53]
    v_pk_mul_f32 v[78:79], v[78:79], v[54:55]
    v_pk_mul_f32 v[80:81], v[80:81], v[56:57]
    v_mfma_f32_16x16x32_bf16 v[110:113], v[62:65], a[228:231], 0
    v_cvt_pk_bf16_f32 v106, v106, v107
    v_cvt_pk_bf16_f32 v107, v108, v109
    v_mfma_f32_16x16x32_bf16 v[110:113], v[58:61], a[232:235], v[110:113]
    v_add_f32 v96, v96, v97
    v_mov_b32 v97, v96
    v_mfma_f32_16x16x32_bf16 v[110:113], v[24:27], a[236:239], v[110:113]
    v_mul_f32 v35, v35, v49
    v_mul_f32 v36, v36, v50
    v_mfma_f32_16x16x32_bf16 v[116:119], v[20:23], a[228:231], 0
    ds_read_b128 v[136:139], v231 offset:12288
    v_mul_f32 v37, v37, v51
    v_mfma_f32_16x16x32_bf16 v[116:119], v[16:19], a[232:235], v[116:119]
    ds_read_b128 v[140:143], v231 offset:14336
    v_cvt_pk_bf16_f32 v108, v110, v111
    v_mfma_f32_16x16x32_bf16 v[116:119], v[12:15], a[236:239], v[116:119]
    ds_read_b128 v[144:147], v231 offset:16384
    v_cvt_pk_bf16_f32 v109, v112, v113
    v_mfma_f32_16x16x32_bf16 v[110:113], v[0:3], a[240:243], 0
    v_permlane32_swap_b32 v96, v97
    v_mfma_f32_16x16x32_bf16 v[110:113], v[8:11], a[244:247], v[110:113]
    v_cvt_pk_bf16_f32 v122, v116, v117
    v_cvt_pk_bf16_f32 v123, v118, v119
    v_mfma_f32_16x16x32_bf16 v[110:113], v[4:7], a[248:251], v[110:113]
    v_add_f32 v96, v96, v97
    v_mov_b32 v97, v96
    v_mfma_f32_16x16x32_bf16 v[116:119], v[62:65], a[240:243], 0
    v_mul_f32 v38, v38, v52
    v_mul_f32 v39, v39, v53
    v_mfma_f32_16x16x32_bf16 v[116:119], v[58:61], a[244:247], v[116:119]
    v_cvt_pk_bf16_f32 v110, v110, v111
    v_cvt_pk_bf16_f32 v111, v112, v113
    v_mfma_f32_16x16x32_bf16 v[116:119], v[24:27], a[248:251], v[116:119]
    v_permlane16_swap_b32 v96, v97
    v_mfma_f32_16x16x32_bf16 v[126:129], v[20:23], a[240:243], 0
    ds_read_b128 v[148:151], v231 offset:13312
    v_add_f32 v96, v96, v97
    v_mfma_f32_16x16x32_bf16 v[126:129], v[16:19], a[244:247], v[126:129]
    ds_read_b128 v[152:155], v231 offset:15360
    v_cvt_pk_bf16_f32 v112, v116, v117
    v_mfma_f32_16x16x32_bf16 v[126:129], v[12:15], a[248:251], v[126:129]
    ds_read_b128 v[156:159], v231 offset:17408
    v_cvt_pk_bf16_f32 v113, v118, v119
    v_mfma_f32_16x16x32_bf16 v[118:121], v[0:3], a[252:255], 0
    s_waitcnt lgkmcnt(7)
    v_add_f32 v96, v96, v94
    v_mul_f32 v94, v94, v186
    v_mfma_f32_16x16x32_bf16 v[118:121], v[8:11], v[40:43], v[118:121]
    s_waitcnt lgkmcnt(6)
    v_cvt_pk_bf16_f32 v126, v126, v127
    v_cvt_pk_bf16_f32 v127, v128, v129
    v_mfma_f32_16x16x32_bf16 v[118:121], v[4:7], v[90:93], v[118:121]
    v_rcp_f32 v96, v96
    v_mfma_f32_16x16x32_bf16 v[128:131], v[62:65], a[252:255], 0
    v_mul_f32 v82, v82, v96
    v_mul_f32 v83, v83, v96
    v_mfma_f32_16x16x32_bf16 v[128:131], v[58:61], v[40:43], v[128:131]
    v_cvt_pk_bf16_f32 v118, v118, v119
    v_cvt_pk_bf16_f32 v119, v120, v121
    v_mfma_f32_16x16x32_bf16 v[128:131], v[24:27], v[90:93], v[128:131]
    v_mul_f32 v84, v84, v96
    v_mul_f32 v85, v85, v96
    v_mfma_f32_16x16x32_bf16 v[160:163], v[20:23], a[252:255], 0
    v_mul_f32 v86, v86, v96
    v_mul_f32 v87, v87, v96
    v_mfma_f32_16x16x32_bf16 v[160:163], v[16:19], v[40:43], v[160:163]
    v_cvt_pk_bf16_f32 v120, v128, v129
    v_cvt_pk_bf16_f32 v121, v130, v131
    v_mfma_f32_16x16x32_bf16 v[160:163], v[12:15], v[90:93], v[160:163]
    s_waitcnt lgkmcnt(5)
    v_mul_f32 v88, v88, v96
    v_mul_f32 v89, v89, v96
    v_mfma_f32_16x16x32_bf16 v[90:93], v[0:3], v[136:139], 0
    s_waitcnt lgkmcnt(4)
    v_cvt_pk_bf16_f32 v40, v82, v83
    v_cvt_pk_bf16_f32 v41, v84, v85
    v_mfma_f32_16x16x32_bf16 v[90:93], v[8:11], v[140:143], v[90:93]
    s_waitcnt lgkmcnt(3)
    v_cvt_pk_bf16_f32 v134, v160, v161
    v_cvt_pk_bf16_f32 v135, v162, v163
    v_mfma_f32_16x16x32_bf16 v[90:93], v[4:7], v[144:147], v[90:93]
    v_cvt_pk_bf16_f32 v42, v86, v87
    v_cvt_pk_bf16_f32 v43, v88, v89
    v_mfma_f32_16x16x32_bf16 v[86:89], v[62:65], v[136:139], 0
    v_mul_f32 v94, v94, v96
    v_mul_f32 v78, v78, v96
    v_mfma_f32_16x16x32_bf16 v[86:89], v[58:61], v[140:143], v[86:89]
    v_cvt_pk_bf16_f32 v130, v90, v91
    v_cvt_pk_bf16_f32 v131, v92, v93
    v_mfma_f32_16x16x32_bf16 v[86:89], v[24:27], v[144:147], v[86:89]
    v_mul_f32 v79, v79, v96
    v_mul_f32 v80, v80, v96
    v_mfma_f32_16x16x32_bf16 v[82:85], v[20:23], v[136:139], 0
    v_mul_f32 v81, v81, v96
    v_cvt_pk_bf16_f32 v94, v94, v94
    v_mfma_f32_16x16x32_bf16 v[82:85], v[16:19], v[140:143], v[82:85]
    v_cvt_pk_bf16_f32 v132, v86, v87
    v_cvt_pk_bf16_f32 v133, v88, v89
    v_mfma_f32_16x16x32_bf16 v[82:85], v[12:15], v[144:147], v[82:85]
    ds_read_b64 v[116:117], v223
    ds_read_b64 v[124:125], v223 offset:32
    s_waitcnt lgkmcnt(4)
    v_mfma_f32_16x16x32_bf16 v[86:89], v[0:3], v[148:151], 0
    ds_read_b64 v[128:129], v223 offset:64
    ds_read_b64 v[136:137], v223 offset:96
    s_waitcnt lgkmcnt(5)
    v_mfma_f32_16x16x32_bf16 v[86:89], v[8:11], v[152:155], v[86:89]
    ds_read_b64 v[140:141], v223 offset:128
    ds_read_b64 v[144:145], v223 offset:160
    s_waitcnt lgkmcnt(6)
    v_mfma_f32_16x16x32_bf16 v[86:89], v[4:7], v[156:159], v[86:89]
    v_cvt_pk_bf16_f32 v138, v82, v83
    v_cvt_pk_bf16_f32 v139, v84, v85
    v_mfma_f32_16x16x32_bf16 v[82:85], v[62:65], v[148:151], 0
    v_cvt_pk_bf16_f32 v78, v78, v79
    v_cvt_pk_bf16_f32 v79, v80, v81
    v_mfma_f32_16x16x32_bf16 v[82:85], v[58:61], v[152:155], v[82:85]
    v_cvt_pk_bf16_f32 v146, v86, v87
    v_cvt_pk_bf16_f32 v147, v88, v89
    v_mfma_f32_16x16x32_bf16 v[82:85], v[24:27], v[156:159], v[82:85]
    v_and_b32 v80, v94, v236
    v_and_b32 v81, v94, v237
    v_mfma_f32_16x16x32_bf16 v[86:89], v[20:23], v[148:151], 0
    v_max3_f32 v45, v32, v33, v34
    v_mul_f32 v28, v28, v54
    v_mfma_f32_16x16x32_bf16 v[86:89], v[16:19], v[152:155], v[86:89]
    v_cvt_pk_bf16_f32 v148, v82, v83
    v_cvt_pk_bf16_f32 v149, v84, v85
    v_mfma_f32_16x16x32_bf16 v[86:89], v[12:15], v[156:159], v[86:89]
    v_mul_f32 v29, v29, v55
    v_mul_f32 v30, v30, v56
    v_mfma_f32_16x16x32_bf16 v[82:85], a[144:147], v[20:23], 0
    v_mul_f32 v31, v31, v57
    v_max3_f32 v99, v35, v36, v37
    v_mfma_f32_16x16x32_bf16 v[82:85], a[148:151], v[16:19], v[82:85]
    v_cvt_pk_bf16_f32 v142, v86, v87
    v_cvt_pk_bf16_f32 v143, v88, v89
    v_mfma_f32_16x16x32_bf16 v[82:85], a[152:155], v[12:15], v[82:85]
    v_max3_f32 v45, v45, v38, v39
    v_mul_f32 v98, v98, v186
    v_mfma_f32_16x16x32_bf16 v[86:89], a[156:159], v[20:23], 0
    v_max3_f32 v99, v99, v28, v29
    v_max3_f32 v45, v45, v30, v31
    v_mfma_f32_16x16x32_bf16 v[86:89], a[160:163], v[16:19], v[86:89]
    v_cvt_pk_bf16_f32 v90, v82, v83
    v_cvt_pk_bf16_f32 v91, v84, v85
    v_mfma_f32_16x16x32_bf16 v[86:89], a[164:167], v[12:15], v[86:89]
    v_max3_f32 v45, v45, v99, v98
    v_mov_b32 v99, v45
    v_mfma_f32_16x16x32_bf16 v[94:97], a[168:171], v[20:23], 0
    v_mfma_f32_16x16x32_bf16 v[94:97], a[172:175], v[16:19], v[94:97]
    v_cvt_pk_bf16_f32 v92, v86, v87
    v_cvt_pk_bf16_f32 v93, v88, v89
    v_mfma_f32_16x16x32_bf16 v[94:97], a[176:179], v[12:15], v[94:97]
    ds_read_b32 v100, v228 offset:128
    v_mfma_f32_16x16x32_bf16 v[82:85], a[180:183], v[20:23], 0
    v_permlane32_swap_b32 v45, v99
    v_mfma_f32_16x16x32_bf16 v[82:85], a[184:187], v[16:19], v[82:85]
    v_cvt_pk_bf16_f32 v94, v94, v95
    v_cvt_pk_bf16_f32 v95, v96, v97
    v_mfma_f32_16x16x32_bf16 v[82:85], a[188:191], v[12:15], v[82:85]
    v_max_f32 v45, v45, v99
    v_mov_b32 v99, v45
    v_mfma_f32_16x16x32_bf16 v[86:89], a[192:195], v[20:23], 0
    v_mfma_f32_16x16x32_bf16 v[86:89], a[196:199], v[16:19], v[86:89]
    v_cvt_pk_bf16_f32 v96, v82, v83
    v_cvt_pk_bf16_f32 v97, v84, v85
    v_mfma_f32_16x16x32_bf16 v[86:89], a[200:203], v[12:15], v[86:89]
    v_permlane16_swap_b32 v45, v99
    v_mfma_f32_16x16x32_bf16 v[82:85], a[204:207], v[20:23], 0
    v_max_f32 v45, v45, v99
    v_mul_f32_e64 v45, -v45, v44
    v_mfma_f32_16x16x32_bf16 v[82:85], a[208:211], v[16:19], v[82:85]
    v_cvt_pk_bf16_f32 v150, v86, v87
    v_cvt_pk_bf16_f32 v151, v88, v89
    v_mfma_f32_16x16x32_bf16 v[82:85], a[212:215], v[12:15], v[82:85]
    v_fma_f32 v32, v32, v44, v45
    v_fma_f32 v33, v33, v44, v45
    v_mfma_f32_16x16x32_bf16 v[86:89], v[102:105], v[40:43], 0
    s_waitcnt lgkmcnt(6)
    v_fma_f32 v34, v34, v44, v45
    v_fma_f32 v35, v35, v44, v45
    v_mfma_f32_16x16x32_bf16 v[86:89], v[114:117], v[78:81], v[86:89]
    v_cvt_pk_bf16_f32 v152, v82, v83
    v_cvt_pk_bf16_f32 v153, v84, v85
    v_mfma_f32_16x16x32_bf16 v[86:89], v[252:255], v[0:3], v[86:89]
    v_fma_f32 v36, v36, v44, v45
    v_fma_f32 v37, v37, v44, v45
    v_mfma_f32_16x16x32_bf16 v[82:85], v[106:109], v[40:43], 0
    s_waitcnt lgkmcnt(5)
    v_fma_f32 v38, v38, v44, v45
    v_fma_f32 v39, v39, v44, v45
    v_mfma_f32_16x16x32_bf16 v[82:85], v[122:125], v[78:81], v[82:85]
    v_cvt_pk_bf16_f32 v86, v86, v87
    v_cvt_pk_bf16_f32 v87, v88, v89
    v_mfma_f32_16x16x32_bf16 v[82:85], v[250:253], v[0:3], v[82:85]
    v_fma_f32 v28, v28, v44, v45
    v_fma_f32 v29, v29, v44, v45
    v_mfma_f32_16x16x32_bf16 v[176:179], v[110:113], v[40:43], 0
    s_waitcnt lgkmcnt(4)
    v_fma_f32 v30, v30, v44, v45
    v_fma_f32 v31, v31, v44, v45
    v_mfma_f32_16x16x32_bf16 v[176:179], v[126:129], v[78:81], v[176:179]
    v_cvt_pk_bf16_f32 v88, v82, v83
    v_cvt_pk_bf16_f32 v89, v84, v85
    v_mfma_f32_16x16x32_bf16 v[176:179], v[252:255], v[8:11], v[176:179]
    ds_write_b128 v226, v[86:89]
    v_mfma_f32_16x16x32_bf16 v[154:157], v[118:121], v[40:43], 0
    s_waitcnt lgkmcnt(4)
    v_exp_f32 v32, v32
    v_mfma_f32_16x16x32_bf16 v[154:157], v[134:137], v[78:81], v[154:157]
    v_exp_f32 v33, v33
    v_mfma_f32_16x16x32_bf16 v[154:157], v[250:253], v[8:11], v[154:157]
    v_exp_f32 v34, v34
    v_mfma_f32_16x16x32_bf16 v[160:163], v[130:133], v[40:43], 0
    s_waitcnt lgkmcnt(3)
    v_exp_f32 v35, v35
    v_mfma_f32_16x16x32_bf16 v[160:163], v[138:141], v[78:81], v[160:163]
    v_exp_f32 v36, v36
    v_mfma_f32_16x16x32_bf16 v[160:163], v[252:255], v[4:7], v[160:163]
    v_exp_f32 v37, v37
    v_mfma_f32_16x16x32_bf16 v[86:89], v[146:149], v[40:43], 0
    s_waitcnt lgkmcnt(2)
    v_exp_f32 v38, v38
    v_mfma_f32_16x16x32_bf16 v[86:89], v[142:145], v[78:81], v[86:89]
    v_exp_f32 v39, v39
    v_mfma_f32_16x16x32_bf16 v[86:89], v[250:253], v[4:7], v[86:89]
    v_exp_f32 v28, v28
    v_mfma_f32_16x16x32_bf16 v[40:43], v[0:3], v[90:93], 0
    v_exp_f32 v29, v29
    v_mfma_f32_16x16x32_bf16 v[40:43], v[8:11], v[94:97], v[40:43]
    v_exp_f32 v30, v30
    v_mfma_f32_16x16x32_bf16 v[40:43], v[4:7], v[150:153], v[40:43]
    ds_read_b128 v[172:175], v222 offset:768
    ds_read_b128 v[168:171], v222 offset:832
    v_mfma_f32_16x16x32_bf16 v[78:81], v[62:65], v[90:93], 0
    ds_read_b128 v[164:167], v222 offset:896
    v_fma_f32 v98, v98, v44, v45
    v_mfma_f32_16x16x32_bf16 v[78:81], v[58:61], v[94:97], v[78:81]
    v_exp_f32 v31, v31
    v_exp_f32 v98, v98
    v_cvt_pk_bf16_f32 v180, v176, v177
    v_pk_add_f32 v[44:45], v[32:33], v[34:35]
    v_pk_add_f32 v[82:83], v[36:37], v[38:39]
    v_pk_add_f32 v[44:45], v[44:45], v[28:29]
    v_pk_add_f32 v[82:83], v[82:83], v[30:31]
    v_pk_add_f32 v[44:45], v[44:45], v[82:83]
    v_pk_mul_f32 v[32:33], v[32:33], v[46:47]
    v_pk_mul_f32 v[34:35], v[34:35], v[48:49]
    v_pk_mul_f32 v[36:37], v[36:37], v[50:51]
    v_pk_mul_f32 v[38:39], v[38:39], v[52:53]
    v_pk_mul_f32 v[28:29], v[28:29], v[54:55]
    v_pk_mul_f32 v[30:31], v[30:31], v[56:57]
    v_mfma_f32_16x16x32_bf16 v[78:81], v[24:27], v[150:153], v[78:81]
    v_add_f32 v44, v44, v45
    v_mov_b32 v45, v44
    v_mfma_f32_16x16x32_bf16 v[82:85], v[20:23], v[90:93], 0
    v_cvt_pk_bf16_f32 v181, v178, v179
    v_cvt_pk_bf16_f32 v182, v154, v155
    v_mfma_f32_16x16x32_bf16 v[82:85], v[16:19], v[94:97], v[82:85]
    v_permlane32_swap_b32 v44, v45
    v_mfma_f32_16x16x32_bf16 v[82:85], v[12:15], v[150:153], v[82:85]
    v_add_f32 v44, v44, v45
    v_mov_b32 v45, v44
    v_mfma_f32_16x16x32_bf16 v[176:179], v[66:69], v[90:93], 0
    v_cvt_pk_bf16_f32 v183, v156, v157
    v_cvt_pk_bf16_f32 v90, v160, v161
    v_mfma_f32_16x16x32_bf16 v[176:179], v[70:73], v[94:97], v[176:179]
    ds_write_b128 v226, v[180:183] offset:64
    v_mfma_f32_16x16x32_bf16 v[176:179], v[74:77], v[150:153], v[176:179]
    s_waitcnt lgkmcnt(3)
    v_permlane16_swap_b32 v44, v45
    v_mfma_f32_16x16x32_bf16 v[150:153], v[0:3], v[172:175], 0
    s_waitcnt lgkmcnt(2)
    v_add_f32 v44, v44, v45
    v_add_f32 v44, v44, v98
    v_mfma_f32_16x16x32_bf16 v[150:153], v[8:11], v[168:171], v[150:153]
    s_waitcnt lgkmcnt(1)
    v_rcp_f32 v44, v44
    v_mfma_f32_16x16x32_bf16 v[150:153], v[4:7], v[164:167], v[150:153]
    v_mul_f32 v32, v32, v44
    v_mul_f32 v33, v33, v44
    v_mfma_f32_16x16x32_bf16 v[158:161], v[62:65], v[172:175], 0
    v_mul_f32 v34, v34, v44
    v_mul_f32 v35, v35, v44
    v_mfma_f32_16x16x32_bf16 v[158:161], v[58:61], v[168:171], v[158:161]
    v_mul_f32 v36, v36, v44
    v_mul_f32 v37, v37, v44
    v_mfma_f32_16x16x32_bf16 v[158:161], v[24:27], v[164:167], v[158:161]
    v_mul_f32 v38, v38, v44
    v_mul_f32 v39, v39, v44
    v_mfma_f32_16x16x32_bf16 v[154:157], v[20:23], v[172:175], 0
    v_cvt_pk_bf16_f32 v4, v32, v33
    v_cvt_pk_bf16_f32 v5, v34, v35
    v_mfma_f32_16x16x32_bf16 v[154:157], v[16:19], v[168:171], v[154:157]
    v_cvt_pk_bf16_f32 v6, v36, v37
    v_cvt_pk_bf16_f32 v7, v38, v39
    v_mfma_f32_16x16x32_bf16 v[154:157], v[12:15], v[164:167], v[154:157]
    v_mul_f32 v98, v98, v186
    v_mul_f32 v98, v98, v44
    v_mfma_f32_16x16x32_bf16 v[182:185], v[66:69], v[172:175], 0
    v_mul_f32 v28, v28, v44
    v_mul_f32 v29, v29, v44
    v_mfma_f32_16x16x32_bf16 v[182:185], v[70:73], v[168:171], v[182:185]
    v_mul_f32 v30, v30, v44
    v_mul_f32 v31, v31, v44
    v_mfma_f32_16x16x32_bf16 v[182:185], v[74:77], v[164:167], v[182:185]
    v_cvt_pk_bf16_f32 v98, v98, v98
    v_cvt_pk_bf16_f32 v32, v28, v29
    v_mfma_f32_16x16x32_bf16 v[0:3], v[102:105], v[4:7], 0
    v_cvt_pk_bf16_f32 v33, v30, v31
    v_and_b32 v34, v98, v236
    v_and_b32 v35, v98, v237
    v_cvt_pk_bf16_f32 v91, v162, v163
    v_mul_f32 v40, v40, v46
    v_mfma_f32_16x16x32_bf16 v[0:3], v[114:117], v[32:35], v[0:3]
    v_mul_f32 v41, v41, v47
    v_mul_f32 v42, v42, v48
    v_mfma_f32_16x16x32_bf16 v[0:3], v[252:255], v[62:65], v[0:3]
    v_mul_f32 v43, v43, v49
    v_mul_f32 v78, v78, v50
    v_mfma_f32_16x16x32_bf16 v[66:69], v[106:109], v[4:7], 0
    v_mul_f32 v79, v79, v51
    v_mul_f32 v80, v80, v52
    v_mfma_f32_16x16x32_bf16 v[66:69], v[122:125], v[32:35], v[66:69]
    v_mul_f32 v81, v81, v53
    v_max3_f32 v44, v40, v41, v42
    v_mfma_f32_16x16x32_bf16 v[66:69], v[250:253], v[62:65], v[66:69]
    v_mul_f32 v82, v82, v54
    v_mul_f32 v83, v83, v55
    v_mfma_f32_16x16x32_bf16 v[8:11], v[110:113], v[4:7], 0
    v_mul_f32 v84, v84, v56
    v_mul_f32 v85, v85, v57
    v_mfma_f32_16x16x32_bf16 v[8:11], v[126:129], v[32:35], v[8:11]
    v_max3_f32 v45, v43, v78, v79
    v_max3_f32 v44, v44, v80, v81
    v_mfma_f32_16x16x32_bf16 v[8:11], v[252:255], v[58:61], v[8:11]
    v_mul_f32_e64 v176, v176, v186
    v_max3_f32 v45, v45, v82, v83
    v_max3_f32 v44, v44, v84, v85
    v_max3_f32 v44, v44, v45, v176
    v_mov_b32 v45, v44
    v_cvt_pk_bf16_f32 v92, v86, v87
    v_cvt_pk_bf16_f32 v93, v88, v89
    v_mfma_f32_16x16x32_bf16 v[28:31], v[118:121], v[4:7], 0
    ds_write_b128 v226, v[90:93] offset:128
    v_mfma_f32_16x16x32_bf16 v[28:31], v[134:137], v[32:35], v[28:31]
    v_permlane32_swap_b32 v44, v45
    v_mfma_f32_16x16x32_bf16 v[28:31], v[250:253], v[58:61], v[28:31]
    ds_read_b128 v[58:61], v230
    v_max_f32 v44, v44, v45
    v_mov_b32 v45, v44
    v_cvt_pk_bf16_f32 v62, v0, v1
    v_cvt_pk_bf16_f32 v63, v2, v3
    v_mfma_f32_16x16x32_bf16 v[0:3], v[130:133], v[4:7], 0
    ds_read_b128 v[36:39], v230 offset:1024
    v_permlane16_swap_b32 v44, v45
    v_mfma_f32_16x16x32_bf16 v[0:3], v[138:141], v[32:35], v[0:3]
    v_max_f32 v44, v44, v45
    v_mul_f32_e64 v101, -v44, v100
    v_mfma_f32_16x16x32_bf16 v[0:3], v[252:255], v[24:27], v[0:3]
    v_fma_f32 v40, v40, v100, v101
    v_fma_f32 v41, v41, v100, v101
    v_fma_f32 v42, v42, v100, v101
    v_fma_f32 v43, v43, v100, v101
    v_fma_f32 v78, v78, v100, v101
    v_fma_f32 v79, v79, v100, v101
    v_fma_f32 v80, v80, v100, v101
    v_fma_f32 v81, v81, v100, v101
    v_fma_f32 v82, v82, v100, v101
    v_fma_f32 v83, v83, v100, v101
    v_fma_f32 v84, v84, v100, v101
    v_fma_f32 v85, v85, v100, v101
    v_exp_f32 v40, v40
    v_exp_f32 v41, v41
    v_exp_f32 v42, v42
    v_exp_f32 v43, v43
    v_exp_f32 v78, v78
    v_exp_f32 v79, v79
    v_exp_f32 v80, v80
    v_exp_f32 v81, v81
    v_exp_f32 v82, v82
    v_exp_f32 v83, v83
    v_exp_f32 v84, v84
    v_exp_f32 v85, v85
    v_cvt_pk_bf16_f32 v64, v66, v67
    v_pk_add_f32 v[44:45], v[40:41], v[42:43]
    v_pk_add_f32 v[66:67], v[78:79], v[80:81]
    v_pk_add_f32 v[44:45], v[44:45], v[82:83]
    v_pk_add_f32 v[66:67], v[66:67], v[84:85]
    v_pk_add_f32 v[44:45], v[44:45], v[66:67]
    v_pk_mul_f32 v[40:41], v[40:41], v[46:47]
    v_pk_mul_f32 v[42:43], v[42:43], v[48:49]
    v_pk_mul_f32 v[78:79], v[78:79], v[50:51]
    v_pk_mul_f32 v[80:81], v[80:81], v[52:53]
    v_pk_mul_f32 v[82:83], v[82:83], v[54:55]
    v_pk_mul_f32 v[84:85], v[84:85], v[56:57]
    v_add_f32 v44, v44, v45
    v_mov_b32 v45, v44
    v_cvt_pk_bf16_f32 v65, v68, v69
    v_mfma_f32_16x16x32_bf16 v[46:49], v[146:149], v[4:7], 0
    ds_write_b128 v226, v[62:65] offset:3072
    v_mfma_f32_16x16x32_bf16 v[46:49], v[142:145], v[32:35], v[46:49]
    s_waitcnt lgkmcnt(2)
    buffer_store_dwordx4 v[58:61], v212, s[8:11], s26 offen nt
    v_mfma_f32_16x16x32_bf16 v[46:49], v[250:253], v[24:27], v[46:49]
    ds_read_b128 v[4:7], v230 offset:2048
    v_permlane32_swap_b32 v44, v45
    v_add_f32 v44, v44, v45
    v_mov_b32 v45, v44
    v_fma_f32 v176, v176, v100, v101
    v_exp_f32 v176, v176
    v_permlane16_swap_b32 v44, v45
    v_add_f32 v44, v44, v45
    v_add_f32 v44, v44, v176
    v_rcp_f32 v44, v44
    v_mul_f32 v176, v176, v186
    v_mul_f32 v40, v40, v44
    v_mul_f32 v41, v41, v44
    v_mul_f32 v42, v42, v44
    v_mul_f32 v43, v43, v44
    v_mul_f32 v78, v78, v44
    v_mul_f32 v79, v79, v44
    v_mul_f32 v80, v80, v44
    v_mul_f32 v81, v81, v44
    v_cvt_pk_bf16_f32 v24, v40, v41
    v_cvt_pk_bf16_f32 v25, v42, v43
    v_cvt_pk_bf16_f32 v26, v78, v79
    v_cvt_pk_bf16_f32 v27, v80, v81
    v_mul_f32 v176, v176, v44
    v_cvt_pk_bf16_f32 v32, v8, v9
    v_cvt_pk_bf16_f32 v33, v10, v11
    v_mfma_f32_16x16x32_bf16 v[8:11], v[102:105], v[24:27], 0
    s_waitcnt lgkmcnt(2)
    buffer_store_dwordx4 v[36:39], v213, s[8:11], s26 offen nt
    v_mul_f32 v82, v82, v44
    v_mul_f32 v83, v83, v44
    v_mul_f32 v84, v84, v44
    v_mul_f32 v85, v85, v44
    v_cvt_pk_bf16_f32 v176, v176, v176
    v_cvt_pk_bf16_f32 v50, v82, v83
    v_cvt_pk_bf16_f32 v51, v84, v85
    v_and_b32 v52, v176, v236
    v_and_b32 v53, v176, v237
    v_cvt_pk_bf16_f32 v34, v28, v29
    v_cvt_pk_bf16_f32 v35, v30, v31
    v_mfma_f32_16x16x32_bf16 v[8:11], v[114:117], v[50:53], v[8:11]
    ds_write_b128 v226, v[32:35] offset:3136
    v_mfma_f32_16x16x32_bf16 v[8:11], v[252:255], v[20:23], v[8:11]
    s_waitcnt lgkmcnt(1)
    buffer_store_dwordx4 v[4:7], v214, s[8:11], s26 offen nt
    v_mfma_f32_16x16x32_bf16 v[54:57], v[106:109], v[24:27], 0
    v_mov_b32_dpp v150, v158 quad_perm:[0,1,2,3] row_mask:0xf bank_mask:0x2
    v_mov_b32_dpp v151, v159 quad_perm:[0,1,2,3] row_mask:0xf bank_mask:0x2
    v_mfma_f32_16x16x32_bf16 v[54:57], v[122:125], v[50:53], v[54:57]
    ds_read_b128 v[40:43], v229
    ds_read_b32 v45, v224
    v_mfma_f32_16x16x32_bf16 v[54:57], v[250:253], v[20:23], v[54:57]
    ds_read_b128 v[36:39], v222
    v_mov_b32_dpp v152, v160 quad_perm:[0,1,2,3] row_mask:0xf bank_mask:0x2
    v_mov_b32_dpp v153, v161 quad_perm:[0,1,2,3] row_mask:0xf bank_mask:0x2
    v_mov_b32_dpp v150, v154 quad_perm:[0,1,2,3] row_mask:0xf bank_mask:0x4
    v_mov_b32_dpp v151, v155 quad_perm:[0,1,2,3] row_mask:0xf bank_mask:0x4
    v_mov_b32_dpp v152, v156 quad_perm:[0,1,2,3] row_mask:0xf bank_mask:0x4
    v_mov_b32_dpp v153, v157 quad_perm:[0,1,2,3] row_mask:0xf bank_mask:0x4
    v_cvt_pk_bf16_f32 v0, v0, v1
    v_cvt_pk_bf16_f32 v1, v2, v3
    v_mfma_f32_16x16x32_bf16 v[58:61], v[110:113], v[24:27], 0
    ds_read_b128 v[32:35], v222 offset:64
    ds_read_b128 v[28:31], v222 offset:128
    v_mfma_f32_16x16x32_bf16 v[58:61], v[126:129], v[50:53], v[58:61]
    v_cvt_pk_bf16_f32 v2, v46, v47
    v_cvt_pk_bf16_f32 v3, v48, v49
    v_mfma_f32_16x16x32_bf16 v[58:61], v[252:255], v[16:19], v[58:61]
    ds_write_b128 v226, v[0:3] offset:3200
    v_mfma_f32_16x16x32_bf16 v[46:49], v[118:121], v[24:27], 0
    v_cvt_pk_bf16_f32 v62, v8, v9
    v_cvt_pk_bf16_f32 v63, v10, v11
    v_mfma_f32_16x16x32_bf16 v[46:49], v[134:137], v[50:53], v[46:49]
    ds_read_b128 v[4:7], v230 offset:3072
    s_waitcnt lgkmcnt(6)
    v_mul_f32 v150, v150, v40
    v_mfma_f32_16x16x32_bf16 v[46:49], v[250:253], v[16:19], v[46:49]
    ds_read_b128 v[0:3], v230 offset:4096
    v_mul_f32 v151, v151, v41
    v_mfma_f32_16x16x32_bf16 v[20:23], v[130:133], v[24:27], 0
    v_mul_f32 v152, v152, v42
    v_mul_f32 v153, v153, v43
    v_mfma_f32_16x16x32_bf16 v[20:23], v[138:141], v[50:53], v[20:23]
    s_waitcnt lgkmcnt(6)
    v_mul_f32 v182, v182, v45
    v_max3_f32 v44, v150, v151, v152
    v_mfma_f32_16x16x32_bf16 v[20:23], v[252:255], v[12:15], v[20:23]
    v_max3_f32 v44, v44, v153, v182
    v_cvt_pk_bf16_f32 v64, v54, v55
    v_cvt_pk_bf16_f32 v65, v56, v57
    v_mfma_f32_16x16x32_bf16 v[8:11], v[146:149], v[24:27], 0
    ds_write_b128 v226, v[62:65] offset:6144
    v_mfma_f32_16x16x32_bf16 v[8:11], v[142:145], v[50:53], v[8:11]
    v_max_f32_dpp v44, v44, v44 row_ror:4 row_mask:0xf bank_mask:0xf
    v_cvt_pk_bf16_f32 v16, v58, v59
    v_mfma_f32_16x16x32_bf16 v[8:11], v[250:253], v[12:15], v[8:11]
    v_max_f32_dpp v44, v44, v44 row_ror:8 row_mask:0xf bank_mask:0xf
    v_mov_b32 v12, v44
    v_cvt_pk_bf16_f32 v17, v60, v61
    v_cvt_pk_bf16_f32 v18, v46, v47
    v_permlane32_swap_b32 v44, v12
    v_max_f32 v44, v44, v12
    v_mov_b32 v12, v44
    v_cvt_pk_bf16_f32 v19, v48, v49
    v_cvt_pk_bf16_f32 v24, v20, v21
    v_permlane16_swap_b32 v44, v12
    v_max_f32 v44, v44, v12
    v_mul_f32_e64 v44, -v44, v45
    v_fma_f32 v150, v150, v45, v44
    v_fma_f32 v151, v151, v45, v44
    v_fma_f32 v152, v152, v45, v44
    v_fma_f32 v153, v153, v45, v44
    v_exp_f32 v150, v150
    v_exp_f32 v151, v151
    v_exp_f32 v152, v152
    v_exp_f32 v153, v153
    v_add_f32 v14, v150, v151
    v_add_f32 v12, v152, v153
    v_add_f32 v14, v14, v12
    v_fma_f32 v182, v182, v45, v44
    v_exp_f32 v182, v182
    v_add_f32_dpp v12, v14, v14 row_shl:4 row_mask:0xf bank_mask:0xf bound_ctrl:0
    v_add_f32_dpp v14, v14, v12 row_shl:8 row_mask:0xf bank_mask:0xf bound_ctrl:0
    v_mov_b32 v12, v14
    v_mul_f32 v150, v150, v40
    v_mul_f32 v151, v151, v41
    v_permlane32_swap_b32 v14, v12
    v_add_f32 v14, v14, v12
    v_mov_b32 v12, v14
    v_mul_f32 v152, v152, v42
    v_mul_f32 v153, v153, v43
    v_permlane16_swap_b32 v14, v12
    v_add_f32 v14, v14, v12
    v_add_f32 v14, v14, v182
    v_rcp_f32 v14, v14
    v_mul_f32_e64 v182, v182, v45
    v_cvt_pk_bf16_f32 v25, v22, v23
    v_mul_f32_dpp v150, v14, v150 row_newbcast:0 row_mask:0xf bank_mask:0xf
    v_mul_f32_dpp v151, v14, v151 row_newbcast:0 row_mask:0xf bank_mask:0xf
    v_mul_f32_dpp v152, v14, v152 row_newbcast:0 row_mask:0xf bank_mask:0xf
    v_mul_f32_dpp v153, v14, v153 row_newbcast:0 row_mask:0xf bank_mask:0xf
    v_cvt_pk_bf16_f32 v12, v150, v151
    v_cvt_pk_bf16_f32 v13, v152, v153
    v_mul_f32_dpp v182, v14, v182 row_newbcast:0 row_mask:0xf bank_mask:0xf
    v_mov_b32_dpp v14, v12 row_shl:4 row_mask:0xf bank_mask:0xf bound_ctrl:0
    v_mov_b32_dpp v15, v13 row_shl:4 row_mask:0xf bank_mask:0xf bound_ctrl:0
    v_cvt_pk_bf16_f32 v182, v182, v182
    v_mov_b32_dpp v20, v12 row_shl:8 row_mask:0xf bank_mask:0xf bound_ctrl:0
    v_mfma_f32_16x16x32_bf16 v[46:49], v[102:105], v[12:15], 0
    ds_write_b128 v226, v[16:19] offset:6208
    s_waitcnt lgkmcnt(3)
    buffer_store_dwordx4 v[4:7], v215, s[8:11], s26 offen nt
    ds_read_b128 v[16:19], v230 offset:5120
    v_mov_b32_dpp v21, v13 row_shl:8 row_mask:0xf bank_mask:0xf bound_ctrl:0
    v_and_b32 v22, v182, v236
    v_and_b32 v23, v182, v237
    v_cvt_pk_bf16_f32 v26, v8, v9
    v_cvt_pk_bf16_f32 v27, v10, v11
    v_mfma_f32_16x16x32_bf16 v[46:49], v[114:117], v[20:23], v[46:49]
    ds_write_b128 v226, v[24:27] offset:6272
    v_mfma_f32_16x16x32_bf16 v[46:49], v[252:255], v[36:39], v[46:49]
    v_mfma_f32_16x16x32_bf16 v[50:53], v[106:109], v[12:15], 0
    ds_read_b128 v[24:27], v230 offset:6144
    v_mfma_f32_16x16x32_bf16 v[50:53], v[122:125], v[20:23], v[50:53]
    ds_read_b128 v[4:7], v230 offset:7168
    v_cvt_pk_bf16_f32 v8, v46, v47
    v_mfma_f32_16x16x32_bf16 v[50:53], v[250:253], v[36:39], v[50:53]
    s_waitcnt lgkmcnt(6)
    buffer_store_dwordx4 v[0:3], v216, s[8:11], s26 offen nt
    v_mfma_f32_16x16x32_bf16 v[54:57], v[110:113], v[12:15], 0
    v_cvt_pk_bf16_f32 v9, v48, v49
    v_mfma_f32_16x16x32_bf16 v[54:57], v[126:129], v[20:23], v[54:57]
    v_cvt_pk_bf16_f32 v10, v50, v51
    v_cvt_pk_bf16_f32 v11, v52, v53
    v_mfma_f32_16x16x32_bf16 v[54:57], v[252:255], v[32:35], v[54:57]
    v_mfma_f32_16x16x32_bf16 v[46:49], v[118:121], v[12:15], 0
    v_mfma_f32_16x16x32_bf16 v[46:49], v[134:137], v[20:23], v[46:49]
    s_waitcnt lgkmcnt(3)
    buffer_store_dwordx4 v[16:19], v217, s[8:11], s26 offen nt
    v_mfma_f32_16x16x32_bf16 v[46:49], v[250:253], v[32:35], v[46:49]
    v_cvt_pk_bf16_f32 v0, v54, v55
    v_cvt_pk_bf16_f32 v1, v56, v57
    v_mfma_f32_16x16x32_bf16 v[16:19], v[130:133], v[12:15], 0
    v_mfma_f32_16x16x32_bf16 v[16:19], v[138:141], v[20:23], v[16:19]
    v_cvt_pk_bf16_f32 v2, v46, v47
    v_cvt_pk_bf16_f32 v3, v48, v49
    v_mfma_f32_16x16x32_bf16 v[16:19], v[252:255], v[28:31], v[16:19]
    v_mfma_f32_16x16x32_bf16 v[46:49], v[146:149], v[12:15], 0
    s_waitcnt lgkmcnt(1)
    buffer_store_dwordx4 v[24:27], v218, s[8:11], s26 offen nt
    v_mfma_f32_16x16x32_bf16 v[46:49], v[142:145], v[20:23], v[46:49]
    ds_read_b128 v[12:15], v230 offset:8192
    v_cvt_pk_bf16_f32 v16, v16, v17
    v_mfma_f32_16x16x32_bf16 v[46:49], v[250:253], v[28:31], v[46:49]
    s_waitcnt lgkmcnt(1)
    v_cvt_pk_bf16_f32 v17, v18, v19
    s_nop 5
    v_cvt_pk_bf16_f32 v18, v46, v47
    v_cvt_pk_bf16_f32 v19, v48, v49
    buffer_store_dwordx4 v[4:7], v219, s[8:11], s26 offen nt
    s_waitcnt lgkmcnt(0)
    buffer_store_dwordx4 v[12:15], v220, s[8:11], s26 offen nt
    buffer_store_dwordx4 v[8:11], v221, s[8:11], s26 offen offset:0 nt
    buffer_store_dwordx4 v[0:3], v221, s[8:11], s26 offen offset:64 nt
    buffer_store_dwordx4 v[16:19], v221, s[8:11], s26 offen offset:128 nt
L_end:
    s_endpgm
L_spin:
    ds_read_b32 v24, v210
    s_waitcnt lgkmcnt(0)
    v_readfirstlane_b32 s63, v24
    s_nop 0
    s_cmp_gt_i32 s63, s62
    s_cbranch_scc1 L_spin
    s_branch L_spin_back
L_claim:
    s_cmp_eq_u32 s55, 9
    s_cbranch_scc1 L_claim_answer
    s_cmp_lg_u32 s20, 0
    s_cbranch_scc1 L_claim_back
    s_load_dwordx2 s[12:13], s[0:1], 48
    s_sub_u32 s46, s53, 2816
    s_and_b32 s47, s46, 15
    s_lshl_b32 s47, s47, 1
    s_lshl_b32 s47, 1, s47
    s_lshr_b32 s46, s46, 4
    s_lshl_b32 s46, s46, 2
    s_mov_b32 s14, 256
    s_mov_b32 s15, 0x00020000
    v_mov_b32 v211, s47
    s_mov_b64 exec, 1
    s_waitcnt lgkmcnt(0)
    buffer_atomic_add v211, off, s[12:15], s46 sc0
    s_mov_b64 exec, -1
L_claim_back:
    s_branch L_loop
L_claim_answer:
    s_cmp_lg_u32 s20, 0
    s_cbranch_scc1 L_claim_read
    v_mov_b32 v12, 162240
    s_mov_b64 exec, 1
    ds_write_b32 v12, v211
    s_mov_b64 exec, -1
    s_waitcnt lgkmcnt(0)
L_claim_read:
    s_barrier
    v_mov_b32 v211, 162240
    ds_read_b32 v211, v211
    s_sub_u32 s46, s53, 2816
    s_and_b32 s48, s46, 15
    s_lshl_b32 s48, s48, 1
    s_waitcnt lgkmcnt(0)
    v_readfirstlane_b32 s47, v211
    s_nop 3
    s_lshr_b32 s47, s47, s48
    s_and_b32 s47, s47, 3
    s_cbranch_scc0 L_claim_won
    s_cmp_lg_u32 s20, 0
    s_cbranch_scc1 L_loop
    s_sub_u32 s49, s46, 2
    s_cmp_lt_u32 s49, 56
    s_cselect_b32 s49, 2, 1
    s_cmp_lg_u32 s47, s49
    s_cbranch_scc1 L_loop
    s_add_u32 s49, s49, 1
    s_lshl_b32 s49, s49, s48
    s_lshr_b32 s46, s46, 4
    s_lshl_b32 s46, s46, 2
    v_mov_b32 v211, s49
    s_mov_b64 exec, 1
    s_nop 0
    buffer_atomic_sub v211, off, s[12:15], s46
    s_mov_b64 exec, -1
    s_branch L_loop
L_claim_won:
    s_mov_b32 s6, 109734912
    s_add_u32 s22, s22, 1
    s_branch L_loop
.section .rodata,"a"
.p2align 6
.amdhsa_kernel standalone__video_video_swin__vision_kernel
  .amdhsa_next_free_vgpr 512
  .amdhsa_next_free_sgpr 102
  .amdhsa_accum_offset 256
  .amdhsa_group_segment_fixed_size 0
  .amdhsa_kernarg_size 64
  .amdhsa_user_sgpr_count 2
  .amdhsa_user_sgpr_kernarg_segment_ptr 1
  .amdhsa_system_sgpr_workgroup_id_x 1
.end_amdhsa_kernel
```
